```python
import torch

def _softmax(x, axis=-1):
    return torch.softmax(x, dim=axis)

def _gelu(x):
    return torch.nn.functional.gelu(x, approximate='tanh')

def _silu(x):
    return torch.nn.functional.silu(x)

def _sigmoid(x):
    return torch.sigmoid(x)

def _layernorm(x, axis=-1, eps=1e-05):
    m = x.mean(dim=axis, keepdim=True)
    v = x.var(dim=axis, keepdim=True, unbiased=False)
    return (x - m) / torch.sqrt(v + eps)

def _scatter_add(tgt, idx, src, axis=0):
    return tgt.clone().index_add_(axis, idx, src)

def _segment_sum(src, seg, n):
    out = torch.zeros((n,) + src.shape[1:], dtype=src.dtype)
    return out.index_add_(0, seg, src)

def _pad(x, pw):
    flat = tuple((v for pair in reversed(pw) for v in pair))
    return torch.nn.functional.pad(x, flat)
kernel_name = 'standalone__autoregressive_conv_wavernn__speech'

def setup_inputs():

    _w = lambda a: (lambda t: t.to(torch.bfloat16) if t.is_floating_point() else t)(torch.as_tensor(a))
    B, T, D, K = (2, 1000, 512, 15)
    return {'x': _w((lambda *s: torch.randn(*s, dtype=torch.bfloat16) * 0.05)(B, T, D)), 'w': _w((lambda *s: torch.randn(*s, dtype=torch.bfloat16) * 0.05)(K, D, 2 * D))}

def reference(x, w):
    B, T, D = x.shape
    K = w.shape[0]
    dil = 2
    pad = (K - 1) * dil
    xp = _pad(x, ((0, 0), (pad, 0), (0, 0)))
    h = torch.einsum('btd,de->bte', xp[:, 0:T, :], w[0])
    for i in range(1, K):
        h = h + torch.einsum('btd,de->bte', xp[:, i * dil:i * dil + T, :], w[i])
    f, g = (h[..., :D].clone(), h[..., D:].clone())
    return torch.tanh(f) * _sigmoid(g)
```

```asm
; @launch grid=(256,1,1) block=(320,1,1) lds=136320
.amdgcn_target "amdgcn-amd-amdhsa--gfx950"
.text
.globl standalone__autoregressive_conv_wavernn__speech_kernel
.p2align 8
.type standalone__autoregressive_conv_wavernn__speech_kernel,@function
standalone__autoregressive_conv_wavernn__speech_kernel:
    s_cmp_ge_u32 s2, 256
    s_cbranch_scc1 L_end
    s_load_dwordx8 s[24:31], s[0:1], 0
    s_load_dwordx2 s[32:33], s[0:1], 32
    v_lshrrev_b32 v12, 6, v0
    v_and_b32 v0, 63, v0
    s_and_b32 s45, s2, 7
    v_readfirstlane_b32 s16, v12
    s_lshl_b32 s45, s45, 7
    s_lshr_b32 s44, s2, 3
    s_and_b32 s43, s44, 1
    s_bfe_u32 s47, s44, 0x10001
    s_cmp_eq_u32 s16, 4
    s_cbranch_scc1 L_helper
    s_lshl_b32 s47, s47, 6
    s_mul_i32 s34, s43, 128
    s_xor_b32 s34, s34, s45
    s_add_u32 s47, s47, s34
    s_lshl_b32 s40, s43, 10
    s_add_u32 s40, s40, s47
    s_lshr_b32 s41, s44, 2
    s_lshr_b32 s42, s41, 2
    s_and_b32 s41, s41, 3
    s_lshl_b32 s41, s41, 8
    s_mul_i32 s42, s42, 1024000
    v_lshrrev_b32 v12, 2, v0
    v_lshlrev_b32 v12, 11, v12
    v_and_b32 v13, 3, v0
    v_lshrrev_b32 v14, 5, v0
    v_lshlrev_b32 v14, 1, v14
    v_xor_b32 v13, v13, v14
    v_lshlrev_b32 v13, 4, v13
    v_add_u32 v12, v12, v13
    s_lshl_b32 s34, s16, 15
    s_add_u32 s34, s34, s40
    v_add_u32 v1, s34, v12
    v_lshrrev_b32 v12, 3, v0
    v_and_b32 v13, 7, v0
    v_lshlrev_b32 v13, 4, v13
    s_lshl_b32 s34, s16, 3
    s_add_u32 s34, s34, s41
    s_sub_u32 s34, s34, 28
    v_add_u32 v12, s34, v12
    v_mov_b32 v15, 0x80000000
    v_cmp_gt_i32 vcc, 0, v12
    v_lshlrev_b32 v14, 10, v12
    v_add_u32 v14, v14, v13
    v_cndmask_b32 v2, v14, v15, vcc
    v_add_u32 v3, 0x8000, v14
    s_lshl_b32 s17, s16, 10
    s_lshr_b32 s56, s16, 1
    s_and_b32 s57, s16, 1
    s_mul_i32 s35, s56, 2080
    s_lshl_b32 s34, s57, 10
    s_add_u32 s35, s35, s34
    s_add_u32 s18, s35, 61440
    s_lshl_b32 s36, s35, 1
    s_add_u32 s36, s36, 160320
    s_mov_b32 s20, 0
    s_mov_b32 s21, 0
    s_waitcnt lgkmcnt(0)
    s_mov_b32 s8, s26
    s_and_b32 s9, s27, 0xffff
    s_mov_b32 s10, 15728640
    s_mov_b32 s11, 0x20000
    s_add_u32 s4, s24, s42
    s_addc_u32 s5, s25, 0
    s_and_b32 s5, s5, 0xffff
    s_mov_b32 s6, 1024000
    s_mov_b32 s7, 0x20000
    s_add_u32 m0, s18, 0
    s_nop 0
    buffer_load_dwordx4 v2, s[4:7], s21 offen lds
    s_add_u32 m0, s18, 4160
    s_add_u32 s37, s21, 0
    buffer_load_dwordx4 v3, s[4:7], s37 offen lds
    s_add_u32 m0, s18, 8320
    s_add_u32 s37, s21, 32768
    buffer_load_dwordx4 v3, s[4:7], s37 offen lds
    s_add_u32 m0, s18, 12480
    s_add_u32 s37, s21, 65536
    buffer_load_dwordx4 v3, s[4:7], s37 offen lds
    s_add_u32 m0, s18, 16640
    s_add_u32 s37, s21, 98304
    buffer_load_dwordx4 v3, s[4:7], s37 offen lds
    s_add_u32 m0, s18, 20800
    s_add_u32 s37, s21, 131072
    buffer_load_dwordx4 v3, s[4:7], s37 offen lds
    s_add_u32 m0, s18, 24960
    s_add_u32 s37, s21, 163840
    buffer_load_dwordx4 v3, s[4:7], s37 offen lds
    s_add_u32 m0, s18, 29120
    s_add_u32 s37, s21, 196608
    buffer_load_dwordx4 v3, s[4:7], s37 offen lds
    s_add_u32 m0, s18, 33280
    s_add_u32 s37, s21, 229376
    buffer_load_dwordx4 v3, s[4:7], s37 offen lds
    s_mov_b32 s22, 0
    s_mov_b32 s20, 131072
    s_mov_b32 s21, 128
    s_sub_u32 s18, s36, s18
    s_add_u32 s12, s28, s42
    s_addc_u32 s13, s29, 0
    s_and_b32 s13, s13, 0xffff
    s_mov_b32 s14, 1024000
    s_mov_b32 s15, 0x20000
    s_mov_b32 s48, s32
    s_and_b32 s49, s33, 0xffff
    s_mov_b32 s50, 0x1000000
    s_mov_b32 s51, 0x20000
    v_lshrrev_b32 v12, 4, v0
    v_lshlrev_b32 v12, 9, v12
    v_bfe_u32 v13, v0, 2, 2
    v_lshlrev_b32 v13, 6, v13
    v_add_u32 v12, v12, v13
    v_and_b32 v13, 3, v0
    v_lshlrev_b32 v13, 3, v13
    v_add_u32 v12, v12, v13
    s_lshl_b32 s34, s56, 11
    v_add_u32 v12, s34, v12
    v_bfe_u32 v13, v0, 4, 1
    v_xor_b32 v13, s43, v13
    v_lshlrev_b32 v13, 5, v13
    v_add_u32 v4, v12, v13
    v_xor_b32 v13, 32, v13
    v_add_u32 v5, v12, v13
    v_bfe_u32 v12, v0, 1, 3
    v_mul_u32_u24 v12, 2080, v12
    v_and_b32 v13, 1, v0
    v_lshlrev_b32 v13, 7, v13
    v_add_u32 v12, v12, v13
    v_lshrrev_b32 v13, 4, v0
    v_lshlrev_b32 v13, 4, v13
    v_add_u32 v12, v12, v13
    s_mul_i32 s34, s57, 16640
    s_lshl_b32 s35, s56, 6
    s_add_u32 s34, s34, s35
    s_add_u32 s34, s34, 61440
    v_add_u32 v6, s34, v12
    v_lshlrev_b32 v7, 1, v6
    v_add_u32 v7, 37440, v7
    v_lshlrev_b32 v12, 4, v0
    s_mov_b32 s38, 0x4038aa3b
    s_mov_b32 s39, 0xbfb8aa3b
    s_cmp_eq_u32 s43, 0
    s_cselect_b32 s38, s38, s39
    s_cselect_b32 s39, -2.0, 1.0
    s_cselect_b32 s46, 1.0, 0
    v_mov_b32 v15, s46
    v_mov_b32 v8, 0x5ca1ab1e
    s_lshl_b32 s34, s16, 12
    s_add_u32 s34, s34, 61440
    v_add_u32 v11, s34, v12
    s_xor_b32 s34, s16, 2
    s_lshl_b32 s34, s34, 12
    s_add_u32 s34, s34, 61440
    v_add_u32 v13, s34, v12
    s_lshl_b32 s23, s2, 2
    s_add_u32 s23, s23, s16
    s_lshl_b32 s23, s23, 12
    s_xor_b32 s58, s2, 9
    s_lshl_b32 s58, s58, 2
    s_add_u32 s58, s58, s16
    s_lshl_b32 s58, s58, 12
    v_bfe_u32 v14, v0, 1, 3
    v_lshlrev_b32 v14, 4, v14
    v_and_b32 v9, 1, v0
    v_add_u32 v14, v14, v9
    s_lshl_b32 s34, s57, 7
    s_add_u32 s34, s34, s41
    s_lshl_b32 s35, s56, 3
    s_add_u32 s34, s34, s35
    v_add_u32 v14, s34, v14
    v_lshlrev_b32 v14, 10, v14
    v_lshrrev_b32 v9, 4, v0
    v_lshlrev_b32 v9, 3, v9
    v_add_u32 v14, v14, v9
    s_xor_b32 s34, s43, 1
    s_lshl_b32 s34, s34, 5
    s_add_u32 s34, s34, s47
    v_add_u32 v14, s34, v14
    v_mov_b32 v136, 0
    v_mov_b32 v137, 0
    v_mov_b32 v138, 0
    v_mov_b32 v139, 0
    v_mov_b32 v140, 0
    v_mov_b32 v141, 0
    v_mov_b32 v142, 0
    v_mov_b32 v143, 0
    v_mov_b32 v144, 0
    v_mov_b32 v145, 0
    v_mov_b32 v146, 0
    v_mov_b32 v147, 0
    v_mov_b32 v148, 0
    v_mov_b32 v149, 0
    v_mov_b32 v150, 0
    v_mov_b32 v151, 0
    v_mov_b32 v152, 0
    v_mov_b32 v153, 0
    v_mov_b32 v154, 0
    v_mov_b32 v155, 0
    v_mov_b32 v156, 0
    v_mov_b32 v157, 0
    v_mov_b32 v158, 0
    v_mov_b32 v159, 0
    v_mov_b32 v160, 0
    v_mov_b32 v161, 0
    v_mov_b32 v162, 0
    v_mov_b32 v163, 0
    v_mov_b32 v164, 0
    v_mov_b32 v165, 0
    v_mov_b32 v166, 0
    v_mov_b32 v167, 0
    v_mov_b32 v168, 0
    v_mov_b32 v169, 0
    v_mov_b32 v170, 0
    v_mov_b32 v171, 0
    v_mov_b32 v172, 0
    v_mov_b32 v173, 0
    v_mov_b32 v174, 0
    v_mov_b32 v175, 0
    v_mov_b32 v176, 0
    v_mov_b32 v177, 0
    v_mov_b32 v178, 0
    v_mov_b32 v179, 0
    v_mov_b32 v180, 0
    v_mov_b32 v181, 0
    v_mov_b32 v182, 0
    v_mov_b32 v183, 0
    v_mov_b32 v184, 0
    v_mov_b32 v185, 0
    v_mov_b32 v186, 0
    v_mov_b32 v187, 0
    v_mov_b32 v188, 0
    v_mov_b32 v189, 0
    v_mov_b32 v190, 0
    v_mov_b32 v191, 0
    v_mov_b32 v192, 0
    v_mov_b32 v193, 0
    v_mov_b32 v194, 0
    v_mov_b32 v195, 0
    v_mov_b32 v196, 0
    v_mov_b32 v197, 0
    v_mov_b32 v198, 0
    v_mov_b32 v199, 0
    s_waitcnt vmcnt(4)
    s_add_u32 m0, s17, 0
    s_add_u32 s37, s22, 0
    buffer_load_dwordx4 v1, s[8:11], s37 offen lds
    s_add_u32 m0, s17, 4096
    s_add_u32 s37, s22, 1048576
    buffer_load_dwordx4 v1, s[8:11], s37 offen lds
    s_add_u32 m0, s17, 8192
    s_add_u32 s37, s22, 2097152
    buffer_load_dwordx4 v1, s[8:11], s37 offen lds
    s_add_u32 m0, s17, 12288
    s_add_u32 s37, s22, 3145728
    buffer_load_dwordx4 v1, s[8:11], s37 offen lds
    s_add_u32 m0, s17, 16384
    s_add_u32 s37, s22, 4194304
    buffer_load_dwordx4 v1, s[8:11], s37 offen lds
    s_add_u32 m0, s17, 20480
    s_add_u32 s37, s22, 5242880
    buffer_load_dwordx4 v1, s[8:11], s37 offen lds
    s_add_u32 m0, s17, 24576
    s_add_u32 s37, s22, 6291456
    buffer_load_dwordx4 v1, s[8:11], s37 offen lds
    s_add_u32 m0, s17, 28672
    s_add_u32 s37, s22, 7340032
    buffer_load_dwordx4 v1, s[8:11], s37 offen lds
    s_add_u32 m0, s17, 32768
    s_add_u32 s37, s22, 8388608
    buffer_load_dwordx4 v1, s[8:11], s37 offen lds
    s_add_u32 m0, s17, 36864
    s_add_u32 s37, s22, 9437184
    buffer_load_dwordx4 v1, s[8:11], s37 offen lds
    s_waitcnt vmcnt(5)
    s_barrier
    ds_read_b64_tr_b16 v[16:17], v4 offset:0
    ds_read_b64_tr_b16 v[18:19], v4 offset:256
    ds_read_b64_tr_b16 v[20:21], v5 offset:0
    ds_read_b64_tr_b16 v[22:23], v5 offset:256
    ds_read_b128 v[48:51], v6 offset:0
    ds_read_b128 v[52:55], v6 offset:256
    ds_read_b128 v[56:59], v6 offset:512
    ds_read_b128 v[60:63], v6 offset:768
    ds_read_b128 v[64:67], v6 offset:1024
    ds_read_b128 v[68:71], v6 offset:1280
    ds_read_b128 v[72:75], v6 offset:1536
    ds_read_b128 v[76:79], v6 offset:1792
    s_mov_b32 s19, 0
L_loop:
    s_waitcnt lgkmcnt(0)
    v_mfma_f32_16x16x32_bf16 v[136:139], v[16:19], v[48:51], v[136:139]
    ds_read_b64_tr_b16 v[24:25], v4 offset:4096
    v_mfma_f32_16x16x32_bf16 v[168:171], v[20:23], v[48:51], v[168:171]
    ds_read_b64_tr_b16 v[26:27], v4 offset:4352
    v_mfma_f32_16x16x32_bf16 v[140:143], v[16:19], v[52:55], v[140:143]
    ds_read_b64_tr_b16 v[28:29], v5 offset:4096
    v_mfma_f32_16x16x32_bf16 v[172:175], v[20:23], v[52:55], v[172:175]
    ds_read_b64_tr_b16 v[30:31], v5 offset:4352
    v_mfma_f32_16x16x32_bf16 v[144:147], v[16:19], v[56:59], v[144:147]
    ds_read_b128 v[80:83], v6 offset:2080
    v_mfma_f32_16x16x32_bf16 v[176:179], v[20:23], v[56:59], v[176:179]
    s_add_u32 m0, s17, 40960
    s_add_u32 s37, s22, 10485760
    v_mfma_f32_16x16x32_bf16 v[148:151], v[16:19], v[60:63], v[148:151]
    buffer_load_dwordx4 v1, s[8:11], s37 offen lds
    v_mfma_f32_16x16x32_bf16 v[180:183], v[20:23], v[60:63], v[180:183]
    v_mfma_f32_16x16x32_bf16 v[152:155], v[16:19], v[64:67], v[152:155]
    v_mfma_f32_16x16x32_bf16 v[184:187], v[20:23], v[64:67], v[184:187]
    v_mfma_f32_16x16x32_bf16 v[156:159], v[16:19], v[68:71], v[156:159]
    v_mfma_f32_16x16x32_bf16 v[188:191], v[20:23], v[68:71], v[188:191]
    v_mfma_f32_16x16x32_bf16 v[160:163], v[16:19], v[72:75], v[160:163]
    v_mfma_f32_16x16x32_bf16 v[192:195], v[20:23], v[72:75], v[192:195]
    v_mfma_f32_16x16x32_bf16 v[164:167], v[16:19], v[76:79], v[164:167]
    v_mfma_f32_16x16x32_bf16 v[196:199], v[20:23], v[76:79], v[196:199]
    s_waitcnt lgkmcnt(0)
    v_mfma_f32_16x16x32_bf16 v[136:139], v[24:27], v[52:55], v[136:139]
    ds_read_b64_tr_b16 v[32:33], v4 offset:8192
    v_mfma_f32_16x16x32_bf16 v[168:171], v[28:31], v[52:55], v[168:171]
    ds_read_b64_tr_b16 v[34:35], v4 offset:8448
    v_mfma_f32_16x16x32_bf16 v[140:143], v[24:27], v[56:59], v[140:143]
    ds_read_b64_tr_b16 v[36:37], v5 offset:8192
    v_mfma_f32_16x16x32_bf16 v[172:175], v[28:31], v[56:59], v[172:175]
    ds_read_b64_tr_b16 v[38:39], v5 offset:8448
    v_mfma_f32_16x16x32_bf16 v[144:147], v[24:27], v[60:63], v[144:147]
    ds_read_b128 v[84:87], v6 offset:2336
    v_mfma_f32_16x16x32_bf16 v[176:179], v[28:31], v[60:63], v[176:179]
    s_add_u32 m0, s17, 45056
    s_add_u32 s37, s22, 11534336
    v_mfma_f32_16x16x32_bf16 v[148:151], v[24:27], v[64:67], v[148:151]
    buffer_load_dwordx4 v1, s[8:11], s37 offen lds
    v_mfma_f32_16x16x32_bf16 v[180:183], v[28:31], v[64:67], v[180:183]
    v_mfma_f32_16x16x32_bf16 v[152:155], v[24:27], v[68:71], v[152:155]
    v_mfma_f32_16x16x32_bf16 v[184:187], v[28:31], v[68:71], v[184:187]
    v_mfma_f32_16x16x32_bf16 v[156:159], v[24:27], v[72:75], v[156:159]
    v_mfma_f32_16x16x32_bf16 v[188:191], v[28:31], v[72:75], v[188:191]
    v_mfma_f32_16x16x32_bf16 v[160:163], v[24:27], v[76:79], v[160:163]
    v_mfma_f32_16x16x32_bf16 v[192:195], v[28:31], v[76:79], v[192:195]
    v_mfma_f32_16x16x32_bf16 v[164:167], v[24:27], v[80:83], v[164:167]
    v_mfma_f32_16x16x32_bf16 v[196:199], v[28:31], v[80:83], v[196:199]
    s_waitcnt lgkmcnt(0)
    v_mfma_f32_16x16x32_bf16 v[136:139], v[32:35], v[56:59], v[136:139]
    ds_read_b64_tr_b16 v[16:17], v4 offset:12288
    v_mfma_f32_16x16x32_bf16 v[168:171], v[36:39], v[56:59], v[168:171]
    ds_read_b64_tr_b16 v[18:19], v4 offset:12544
    v_mfma_f32_16x16x32_bf16 v[140:143], v[32:35], v[60:63], v[140:143]
    ds_read_b64_tr_b16 v[20:21], v5 offset:12288
    v_mfma_f32_16x16x32_bf16 v[172:175], v[36:39], v[60:63], v[172:175]
    ds_read_b64_tr_b16 v[22:23], v5 offset:12544
    v_mfma_f32_16x16x32_bf16 v[144:147], v[32:35], v[64:67], v[144:147]
    ds_read_b128 v[88:91], v6 offset:2592
    v_mfma_f32_16x16x32_bf16 v[176:179], v[36:39], v[64:67], v[176:179]
    s_add_u32 m0, s17, 49152
    s_add_u32 s37, s22, 12582912
    v_mfma_f32_16x16x32_bf16 v[148:151], v[32:35], v[68:71], v[148:151]
    buffer_load_dwordx4 v1, s[8:11], s37 offen lds
    v_mfma_f32_16x16x32_bf16 v[180:183], v[36:39], v[68:71], v[180:183]
    v_mfma_f32_16x16x32_bf16 v[152:155], v[32:35], v[72:75], v[152:155]
    v_mfma_f32_16x16x32_bf16 v[184:187], v[36:39], v[72:75], v[184:187]
    v_mfma_f32_16x16x32_bf16 v[156:159], v[32:35], v[76:79], v[156:159]
    v_mfma_f32_16x16x32_bf16 v[188:191], v[36:39], v[76:79], v[188:191]
    v_mfma_f32_16x16x32_bf16 v[160:163], v[32:35], v[80:83], v[160:163]
    v_mfma_f32_16x16x32_bf16 v[192:195], v[36:39], v[80:83], v[192:195]
    v_mfma_f32_16x16x32_bf16 v[164:167], v[32:35], v[84:87], v[164:167]
    v_mfma_f32_16x16x32_bf16 v[196:199], v[36:39], v[84:87], v[196:199]
    s_waitcnt lgkmcnt(0)
    v_mfma_f32_16x16x32_bf16 v[136:139], v[16:19], v[60:63], v[136:139]
    ds_read_b64_tr_b16 v[24:25], v4 offset:16384
    v_mfma_f32_16x16x32_bf16 v[168:171], v[20:23], v[60:63], v[168:171]
    ds_read_b64_tr_b16 v[26:27], v4 offset:16640
    v_mfma_f32_16x16x32_bf16 v[140:143], v[16:19], v[64:67], v[140:143]
    ds_read_b64_tr_b16 v[28:29], v5 offset:16384
    v_mfma_f32_16x16x32_bf16 v[172:175], v[20:23], v[64:67], v[172:175]
    ds_read_b64_tr_b16 v[30:31], v5 offset:16640
    v_mfma_f32_16x16x32_bf16 v[144:147], v[16:19], v[68:71], v[144:147]
    ds_read_b128 v[92:95], v6 offset:2848
    v_mfma_f32_16x16x32_bf16 v[176:179], v[20:23], v[68:71], v[176:179]
    s_add_u32 m0, s17, 53248
    s_add_u32 s37, s22, 13631488
    v_mfma_f32_16x16x32_bf16 v[148:151], v[16:19], v[72:75], v[148:151]
    buffer_load_dwordx4 v1, s[8:11], s37 offen lds
    v_mfma_f32_16x16x32_bf16 v[180:183], v[20:23], v[72:75], v[180:183]
    v_mfma_f32_16x16x32_bf16 v[152:155], v[16:19], v[76:79], v[152:155]
    v_mfma_f32_16x16x32_bf16 v[184:187], v[20:23], v[76:79], v[184:187]
    v_mfma_f32_16x16x32_bf16 v[156:159], v[16:19], v[80:83], v[156:159]
    v_mfma_f32_16x16x32_bf16 v[188:191], v[20:23], v[80:83], v[188:191]
    v_mfma_f32_16x16x32_bf16 v[160:163], v[16:19], v[84:87], v[160:163]
    v_mfma_f32_16x16x32_bf16 v[192:195], v[20:23], v[84:87], v[192:195]
    v_mfma_f32_16x16x32_bf16 v[164:167], v[16:19], v[88:91], v[164:167]
    v_mfma_f32_16x16x32_bf16 v[196:199], v[20:23], v[88:91], v[196:199]
    s_waitcnt lgkmcnt(0)
    v_mfma_f32_16x16x32_bf16 v[136:139], v[24:27], v[64:67], v[136:139]
    v_mfma_f32_16x16x32_bf16 v[168:171], v[28:31], v[64:67], v[168:171]
    s_waitcnt vmcnt(4)
    s_barrier
    v_mfma_f32_16x16x32_bf16 v[140:143], v[24:27], v[68:71], v[140:143]
    ds_read_b64_tr_b16 v[32:33], v4 offset:20480
    v_mfma_f32_16x16x32_bf16 v[172:175], v[28:31], v[68:71], v[172:175]
    ds_read_b64_tr_b16 v[34:35], v4 offset:20736
    v_mfma_f32_16x16x32_bf16 v[144:147], v[24:27], v[72:75], v[144:147]
    ds_read_b64_tr_b16 v[36:37], v5 offset:20480
    v_mfma_f32_16x16x32_bf16 v[176:179], v[28:31], v[72:75], v[176:179]
    ds_read_b64_tr_b16 v[38:39], v5 offset:20736
    v_mfma_f32_16x16x32_bf16 v[148:151], v[24:27], v[76:79], v[148:151]
    ds_read_b128 v[96:99], v6 offset:3104
    v_mfma_f32_16x16x32_bf16 v[180:183], v[28:31], v[76:79], v[180:183]
    s_add_u32 m0, s17, 57344
    s_add_u32 s37, s22, 14680064
    v_mfma_f32_16x16x32_bf16 v[152:155], v[24:27], v[80:83], v[152:155]
    buffer_load_dwordx4 v1, s[8:11], s37 offen lds
    v_mfma_f32_16x16x32_bf16 v[184:187], v[28:31], v[80:83], v[184:187]
    v_mfma_f32_16x16x32_bf16 v[156:159], v[24:27], v[84:87], v[156:159]
    v_mfma_f32_16x16x32_bf16 v[188:191], v[28:31], v[84:87], v[188:191]
    v_mfma_f32_16x16x32_bf16 v[160:163], v[24:27], v[88:91], v[160:163]
    v_mfma_f32_16x16x32_bf16 v[192:195], v[28:31], v[88:91], v[192:195]
    v_mfma_f32_16x16x32_bf16 v[164:167], v[24:27], v[92:95], v[164:167]
    v_mfma_f32_16x16x32_bf16 v[196:199], v[28:31], v[92:95], v[196:199]
    s_waitcnt lgkmcnt(0)
    v_mfma_f32_16x16x32_bf16 v[136:139], v[32:35], v[68:71], v[136:139]
    ds_read_b64_tr_b16 v[16:17], v4 offset:24576
    v_mfma_f32_16x16x32_bf16 v[168:171], v[36:39], v[68:71], v[168:171]
    ds_read_b64_tr_b16 v[18:19], v4 offset:24832
    v_mfma_f32_16x16x32_bf16 v[140:143], v[32:35], v[72:75], v[140:143]
    ds_read_b64_tr_b16 v[20:21], v5 offset:24576
    v_mfma_f32_16x16x32_bf16 v[172:175], v[36:39], v[72:75], v[172:175]
    ds_read_b64_tr_b16 v[22:23], v5 offset:24832
    v_mfma_f32_16x16x32_bf16 v[144:147], v[32:35], v[76:79], v[144:147]
    ds_read_b128 v[100:103], v6 offset:3360
    v_mfma_f32_16x16x32_bf16 v[176:179], v[36:39], v[76:79], v[176:179]
    s_add_u32 m0, s17, 0
    s_add_u32 s37, s20, 0
    v_mfma_f32_16x16x32_bf16 v[148:151], v[32:35], v[80:83], v[148:151]
    buffer_load_dwordx4 v1, s[8:11], s37 offen lds
    v_mfma_f32_16x16x32_bf16 v[180:183], v[36:39], v[80:83], v[180:183]
    v_mfma_f32_16x16x32_bf16 v[152:155], v[32:35], v[84:87], v[152:155]
    v_mfma_f32_16x16x32_bf16 v[184:187], v[36:39], v[84:87], v[184:187]
    v_mfma_f32_16x16x32_bf16 v[156:159], v[32:35], v[88:91], v[156:159]
    v_mfma_f32_16x16x32_bf16 v[188:191], v[36:39], v[88:91], v[188:191]
    v_mfma_f32_16x16x32_bf16 v[160:163], v[32:35], v[92:95], v[160:163]
    v_mfma_f32_16x16x32_bf16 v[192:195], v[36:39], v[92:95], v[192:195]
    v_mfma_f32_16x16x32_bf16 v[164:167], v[32:35], v[96:99], v[164:167]
    v_mfma_f32_16x16x32_bf16 v[196:199], v[36:39], v[96:99], v[196:199]
    s_waitcnt lgkmcnt(0)
    v_mfma_f32_16x16x32_bf16 v[136:139], v[16:19], v[72:75], v[136:139]
    ds_read_b64_tr_b16 v[24:25], v4 offset:28672
    v_mfma_f32_16x16x32_bf16 v[168:171], v[20:23], v[72:75], v[168:171]
    ds_read_b64_tr_b16 v[26:27], v4 offset:28928
    v_mfma_f32_16x16x32_bf16 v[140:143], v[16:19], v[76:79], v[140:143]
    ds_read_b64_tr_b16 v[28:29], v5 offset:28672
    v_mfma_f32_16x16x32_bf16 v[172:175], v[20:23], v[76:79], v[172:175]
    ds_read_b64_tr_b16 v[30:31], v5 offset:28928
    v_mfma_f32_16x16x32_bf16 v[144:147], v[16:19], v[80:83], v[144:147]
    ds_read_b128 v[104:107], v6 offset:3616
    v_mfma_f32_16x16x32_bf16 v[176:179], v[20:23], v[80:83], v[176:179]
    s_add_u32 m0, s17, 4096
    s_add_u32 s37, s20, 1048576
    v_mfma_f32_16x16x32_bf16 v[148:151], v[16:19], v[84:87], v[148:151]
    buffer_load_dwordx4 v1, s[8:11], s37 offen lds
    v_mfma_f32_16x16x32_bf16 v[180:183], v[20:23], v[84:87], v[180:183]
    v_mfma_f32_16x16x32_bf16 v[152:155], v[16:19], v[88:91], v[152:155]
    s_add_u32 m0, s17, 8192
    s_add_u32 s37, s20, 2097152
    v_mfma_f32_16x16x32_bf16 v[184:187], v[20:23], v[88:91], v[184:187]
    buffer_load_dwordx4 v1, s[8:11], s37 offen lds
    v_mfma_f32_16x16x32_bf16 v[156:159], v[16:19], v[92:95], v[156:159]
    v_mfma_f32_16x16x32_bf16 v[188:191], v[20:23], v[92:95], v[188:191]
    v_mfma_f32_16x16x32_bf16 v[160:163], v[16:19], v[96:99], v[160:163]
    v_mfma_f32_16x16x32_bf16 v[192:195], v[20:23], v[96:99], v[192:195]
    v_mfma_f32_16x16x32_bf16 v[164:167], v[16:19], v[100:103], v[164:167]
    v_mfma_f32_16x16x32_bf16 v[196:199], v[20:23], v[100:103], v[196:199]
    s_waitcnt lgkmcnt(0)
    v_mfma_f32_16x16x32_bf16 v[136:139], v[24:27], v[76:79], v[136:139]
    ds_read_b64_tr_b16 v[32:33], v4 offset:32768
    v_mfma_f32_16x16x32_bf16 v[168:171], v[28:31], v[76:79], v[168:171]
    ds_read_b64_tr_b16 v[34:35], v4 offset:33024
    v_mfma_f32_16x16x32_bf16 v[140:143], v[24:27], v[80:83], v[140:143]
    ds_read_b64_tr_b16 v[36:37], v5 offset:32768
    v_mfma_f32_16x16x32_bf16 v[172:175], v[28:31], v[80:83], v[172:175]
    ds_read_b64_tr_b16 v[38:39], v5 offset:33024
    v_mfma_f32_16x16x32_bf16 v[144:147], v[24:27], v[84:87], v[144:147]
    ds_read_b128 v[108:111], v6 offset:3872
    v_mfma_f32_16x16x32_bf16 v[176:179], v[28:31], v[84:87], v[176:179]
    s_add_u32 m0, s17, 12288
    s_add_u32 s37, s20, 3145728
    v_mfma_f32_16x16x32_bf16 v[148:151], v[24:27], v[88:91], v[148:151]
    buffer_load_dwordx4 v1, s[8:11], s37 offen lds
    v_mfma_f32_16x16x32_bf16 v[180:183], v[28:31], v[88:91], v[180:183]
    v_mfma_f32_16x16x32_bf16 v[152:155], v[24:27], v[92:95], v[152:155]
    s_add_u32 m0, s17, 16384
    s_add_u32 s37, s20, 4194304
    v_mfma_f32_16x16x32_bf16 v[184:187], v[28:31], v[92:95], v[184:187]
    buffer_load_dwordx4 v1, s[8:11], s37 offen lds
    v_mfma_f32_16x16x32_bf16 v[156:159], v[24:27], v[96:99], v[156:159]
    v_mfma_f32_16x16x32_bf16 v[188:191], v[28:31], v[96:99], v[188:191]
    s_add_u32 m0, s18, 0
    s_nop 0
    v_mfma_f32_16x16x32_bf16 v[160:163], v[24:27], v[100:103], v[160:163]
    buffer_load_dwordx4 v2, s[4:7], s21 offen lds
    v_mfma_f32_16x16x32_bf16 v[192:195], v[28:31], v[100:103], v[192:195]
    v_mfma_f32_16x16x32_bf16 v[164:167], v[24:27], v[104:107], v[164:167]
    v_mfma_f32_16x16x32_bf16 v[196:199], v[28:31], v[104:107], v[196:199]
    s_waitcnt lgkmcnt(0)
    v_mfma_f32_16x16x32_bf16 v[136:139], v[32:35], v[80:83], v[136:139]
    ds_read_b64_tr_b16 v[16:17], v4 offset:36864
    v_mfma_f32_16x16x32_bf16 v[168:171], v[36:39], v[80:83], v[168:171]
    ds_read_b64_tr_b16 v[18:19], v4 offset:37120
    v_mfma_f32_16x16x32_bf16 v[140:143], v[32:35], v[84:87], v[140:143]
    ds_read_b64_tr_b16 v[20:21], v5 offset:36864
    v_mfma_f32_16x16x32_bf16 v[172:175], v[36:39], v[84:87], v[172:175]
    ds_read_b64_tr_b16 v[22:23], v5 offset:37120
    v_mfma_f32_16x16x32_bf16 v[144:147], v[32:35], v[88:91], v[144:147]
    ds_read_b128 v[112:115], v6 offset:4160
    v_mfma_f32_16x16x32_bf16 v[176:179], v[36:39], v[88:91], v[176:179]
    s_add_u32 m0, s18, 4160
    s_add_u32 s37, s21, 0
    v_mfma_f32_16x16x32_bf16 v[148:151], v[32:35], v[92:95], v[148:151]
    buffer_load_dwordx4 v3, s[4:7], s37 offen lds
    v_mfma_f32_16x16x32_bf16 v[180:183], v[36:39], v[92:95], v[180:183]
    v_mfma_f32_16x16x32_bf16 v[152:155], v[32:35], v[96:99], v[152:155]
    s_add_u32 m0, s18, 8320
    s_add_u32 s37, s21, 32768
    v_mfma_f32_16x16x32_bf16 v[184:187], v[36:39], v[96:99], v[184:187]
    buffer_load_dwordx4 v3, s[4:7], s37 offen lds
    v_mfma_f32_16x16x32_bf16 v[156:159], v[32:35], v[100:103], v[156:159]
    v_mfma_f32_16x16x32_bf16 v[188:191], v[36:39], v[100:103], v[188:191]
    s_add_u32 m0, s18, 12480
    s_add_u32 s37, s21, 65536
    v_mfma_f32_16x16x32_bf16 v[160:163], v[32:35], v[104:107], v[160:163]
    buffer_load_dwordx4 v3, s[4:7], s37 offen lds
    v_mfma_f32_16x16x32_bf16 v[192:195], v[36:39], v[104:107], v[192:195]
    v_mfma_f32_16x16x32_bf16 v[164:167], v[32:35], v[108:111], v[164:167]
    v_mfma_f32_16x16x32_bf16 v[196:199], v[36:39], v[108:111], v[196:199]
    s_waitcnt lgkmcnt(0)
    v_mfma_f32_16x16x32_bf16 v[136:139], v[16:19], v[84:87], v[136:139]
    v_mfma_f32_16x16x32_bf16 v[168:171], v[20:23], v[84:87], v[168:171]
    s_waitcnt vmcnt(9)
    s_barrier
    v_mfma_f32_16x16x32_bf16 v[140:143], v[16:19], v[88:91], v[140:143]
    ds_read_b64_tr_b16 v[24:25], v4 offset:40960
    v_mfma_f32_16x16x32_bf16 v[172:175], v[20:23], v[88:91], v[172:175]
    ds_read_b64_tr_b16 v[26:27], v4 offset:41216
    v_mfma_f32_16x16x32_bf16 v[144:147], v[16:19], v[92:95], v[144:147]
    ds_read_b64_tr_b16 v[28:29], v5 offset:40960
    v_mfma_f32_16x16x32_bf16 v[176:179], v[20:23], v[92:95], v[176:179]
    ds_read_b64_tr_b16 v[30:31], v5 offset:41216
    v_mfma_f32_16x16x32_bf16 v[148:151], v[16:19], v[96:99], v[148:151]
    ds_read_b128 v[116:119], v6 offset:4416
    v_mfma_f32_16x16x32_bf16 v[180:183], v[20:23], v[96:99], v[180:183]
    s_add_u32 m0, s18, 16640
    s_add_u32 s37, s21, 98304
    v_mfma_f32_16x16x32_bf16 v[152:155], v[16:19], v[100:103], v[152:155]
    buffer_load_dwordx4 v3, s[4:7], s37 offen lds
    v_mfma_f32_16x16x32_bf16 v[184:187], v[20:23], v[100:103], v[184:187]
    v_mfma_f32_16x16x32_bf16 v[156:159], v[16:19], v[104:107], v[156:159]
    s_add_u32 m0, s18, 20800
    s_add_u32 s37, s21, 131072
    v_mfma_f32_16x16x32_bf16 v[188:191], v[20:23], v[104:107], v[188:191]
    buffer_load_dwordx4 v3, s[4:7], s37 offen lds
    v_mfma_f32_16x16x32_bf16 v[160:163], v[16:19], v[108:111], v[160:163]
    v_mfma_f32_16x16x32_bf16 v[192:195], v[20:23], v[108:111], v[192:195]
    v_mfma_f32_16x16x32_bf16 v[164:167], v[16:19], v[112:115], v[164:167]
    v_mfma_f32_16x16x32_bf16 v[196:199], v[20:23], v[112:115], v[196:199]
    s_waitcnt lgkmcnt(0)
    v_mfma_f32_16x16x32_bf16 v[136:139], v[24:27], v[88:91], v[136:139]
    ds_read_b64_tr_b16 v[32:33], v4 offset:45056
    v_mfma_f32_16x16x32_bf16 v[168:171], v[28:31], v[88:91], v[168:171]
    ds_read_b64_tr_b16 v[34:35], v4 offset:45312
    v_mfma_f32_16x16x32_bf16 v[140:143], v[24:27], v[92:95], v[140:143]
    ds_read_b64_tr_b16 v[36:37], v5 offset:45056
    v_mfma_f32_16x16x32_bf16 v[172:175], v[28:31], v[92:95], v[172:175]
    ds_read_b64_tr_b16 v[38:39], v5 offset:45312
    v_mfma_f32_16x16x32_bf16 v[144:147], v[24:27], v[96:99], v[144:147]
    ds_read_b128 v[120:123], v6 offset:4672
    v_mfma_f32_16x16x32_bf16 v[176:179], v[28:31], v[96:99], v[176:179]
    s_add_u32 m0, s18, 24960
    s_add_u32 s37, s21, 163840
    v_mfma_f32_16x16x32_bf16 v[148:151], v[24:27], v[100:103], v[148:151]
    buffer_load_dwordx4 v3, s[4:7], s37 offen lds
    v_mfma_f32_16x16x32_bf16 v[180:183], v[28:31], v[100:103], v[180:183]
    v_mfma_f32_16x16x32_bf16 v[152:155], v[24:27], v[104:107], v[152:155]
    s_add_u32 m0, s18, 29120
    s_add_u32 s37, s21, 196608
    v_mfma_f32_16x16x32_bf16 v[184:187], v[28:31], v[104:107], v[184:187]
    buffer_load_dwordx4 v3, s[4:7], s37 offen lds
    v_mfma_f32_16x16x32_bf16 v[156:159], v[24:27], v[108:111], v[156:159]
    v_mfma_f32_16x16x32_bf16 v[188:191], v[28:31], v[108:111], v[188:191]
    s_add_u32 m0, s18, 33280
    s_add_u32 s37, s21, 229376
    v_mfma_f32_16x16x32_bf16 v[160:163], v[24:27], v[112:115], v[160:163]
    buffer_load_dwordx4 v3, s[4:7], s37 offen lds
    v_mfma_f32_16x16x32_bf16 v[192:195], v[28:31], v[112:115], v[192:195]
    v_mfma_f32_16x16x32_bf16 v[164:167], v[24:27], v[116:119], v[164:167]
    v_mfma_f32_16x16x32_bf16 v[196:199], v[28:31], v[116:119], v[196:199]
    s_waitcnt lgkmcnt(0)
    v_mfma_f32_16x16x32_bf16 v[136:139], v[32:35], v[92:95], v[136:139]
    ds_read_b64_tr_b16 v[16:17], v4 offset:49152
    v_mfma_f32_16x16x32_bf16 v[168:171], v[36:39], v[92:95], v[168:171]
    ds_read_b64_tr_b16 v[18:19], v4 offset:49408
    v_mfma_f32_16x16x32_bf16 v[140:143], v[32:35], v[96:99], v[140:143]
    ds_read_b64_tr_b16 v[20:21], v5 offset:49152
    v_mfma_f32_16x16x32_bf16 v[172:175], v[36:39], v[96:99], v[172:175]
    ds_read_b64_tr_b16 v[22:23], v5 offset:49408
    v_mfma_f32_16x16x32_bf16 v[144:147], v[32:35], v[100:103], v[144:147]
    ds_read_b128 v[124:127], v6 offset:4928
    v_mfma_f32_16x16x32_bf16 v[176:179], v[36:39], v[100:103], v[176:179]
    s_add_u32 m0, s17, 20480
    s_add_u32 s37, s20, 5242880
    v_mfma_f32_16x16x32_bf16 v[148:151], v[32:35], v[104:107], v[148:151]
    buffer_load_dwordx4 v1, s[8:11], s37 offen lds
    v_mfma_f32_16x16x32_bf16 v[180:183], v[36:39], v[104:107], v[180:183]
    v_mfma_f32_16x16x32_bf16 v[152:155], v[32:35], v[108:111], v[152:155]
    s_add_u32 m0, s17, 24576
    s_add_u32 s37, s20, 6291456
    v_mfma_f32_16x16x32_bf16 v[184:187], v[36:39], v[108:111], v[184:187]
    buffer_load_dwordx4 v1, s[8:11], s37 offen lds
    v_mfma_f32_16x16x32_bf16 v[156:159], v[32:35], v[112:115], v[156:159]
    v_mfma_f32_16x16x32_bf16 v[188:191], v[36:39], v[112:115], v[188:191]
    v_mfma_f32_16x16x32_bf16 v[160:163], v[32:35], v[116:119], v[160:163]
    v_mfma_f32_16x16x32_bf16 v[192:195], v[36:39], v[116:119], v[192:195]
    v_mfma_f32_16x16x32_bf16 v[164:167], v[32:35], v[120:123], v[164:167]
    v_mfma_f32_16x16x32_bf16 v[196:199], v[36:39], v[120:123], v[196:199]
    s_waitcnt lgkmcnt(0)
    v_mfma_f32_16x16x32_bf16 v[136:139], v[16:19], v[96:99], v[136:139]
    ds_read_b64_tr_b16 v[24:25], v4 offset:53248
    v_mfma_f32_16x16x32_bf16 v[168:171], v[20:23], v[96:99], v[168:171]
    ds_read_b64_tr_b16 v[26:27], v4 offset:53504
    v_mfma_f32_16x16x32_bf16 v[140:143], v[16:19], v[100:103], v[140:143]
    ds_read_b64_tr_b16 v[28:29], v5 offset:53248
    v_mfma_f32_16x16x32_bf16 v[172:175], v[20:23], v[100:103], v[172:175]
    ds_read_b64_tr_b16 v[30:31], v5 offset:53504
    v_mfma_f32_16x16x32_bf16 v[144:147], v[16:19], v[104:107], v[144:147]
    ds_read_b128 v[128:131], v6 offset:5184
    v_mfma_f32_16x16x32_bf16 v[176:179], v[20:23], v[104:107], v[176:179]
    s_add_u32 m0, s17, 28672
    s_add_u32 s37, s20, 7340032
    v_mfma_f32_16x16x32_bf16 v[148:151], v[16:19], v[108:111], v[148:151]
    buffer_load_dwordx4 v1, s[8:11], s37 offen lds
    v_mfma_f32_16x16x32_bf16 v[180:183], v[20:23], v[108:111], v[180:183]
    v_mfma_f32_16x16x32_bf16 v[152:155], v[16:19], v[112:115], v[152:155]
    s_add_u32 m0, s17, 32768
    s_add_u32 s37, s20, 8388608
    v_mfma_f32_16x16x32_bf16 v[184:187], v[20:23], v[112:115], v[184:187]
    buffer_load_dwordx4 v1, s[8:11], s37 offen lds
    v_mfma_f32_16x16x32_bf16 v[156:159], v[16:19], v[116:119], v[156:159]
    v_mfma_f32_16x16x32_bf16 v[188:191], v[20:23], v[116:119], v[188:191]
    v_mfma_f32_16x16x32_bf16 v[160:163], v[16:19], v[120:123], v[160:163]
    v_mfma_f32_16x16x32_bf16 v[192:195], v[20:23], v[120:123], v[192:195]
    v_mfma_f32_16x16x32_bf16 v[164:167], v[16:19], v[124:127], v[164:167]
    v_mfma_f32_16x16x32_bf16 v[196:199], v[20:23], v[124:127], v[196:199]
    s_waitcnt lgkmcnt(0)
    v_mfma_f32_16x16x32_bf16 v[136:139], v[24:27], v[100:103], v[136:139]
    ds_read_b64_tr_b16 v[32:33], v4 offset:57344
    v_mfma_f32_16x16x32_bf16 v[168:171], v[28:31], v[100:103], v[168:171]
    ds_read_b64_tr_b16 v[34:35], v4 offset:57600
    v_mfma_f32_16x16x32_bf16 v[140:143], v[24:27], v[104:107], v[140:143]
    ds_read_b64_tr_b16 v[36:37], v5 offset:57344
    v_mfma_f32_16x16x32_bf16 v[172:175], v[28:31], v[104:107], v[172:175]
    ds_read_b64_tr_b16 v[38:39], v5 offset:57600
    v_mfma_f32_16x16x32_bf16 v[144:147], v[24:27], v[108:111], v[144:147]
    ds_read_b128 v[132:135], v6 offset:5440
    v_mfma_f32_16x16x32_bf16 v[176:179], v[28:31], v[108:111], v[176:179]
    s_add_u32 m0, s17, 36864
    s_add_u32 s37, s20, 9437184
    v_mfma_f32_16x16x32_bf16 v[148:151], v[24:27], v[112:115], v[148:151]
    buffer_load_dwordx4 v1, s[8:11], s37 offen lds
    v_mfma_f32_16x16x32_bf16 v[180:183], v[28:31], v[112:115], v[180:183]
    v_mfma_f32_16x16x32_bf16 v[152:155], v[24:27], v[116:119], v[152:155]
    v_mfma_f32_16x16x32_bf16 v[184:187], v[28:31], v[116:119], v[184:187]
    v_mfma_f32_16x16x32_bf16 v[156:159], v[24:27], v[120:123], v[156:159]
    v_mfma_f32_16x16x32_bf16 v[188:191], v[28:31], v[120:123], v[188:191]
    v_mfma_f32_16x16x32_bf16 v[160:163], v[24:27], v[124:127], v[160:163]
    v_mfma_f32_16x16x32_bf16 v[192:195], v[28:31], v[124:127], v[192:195]
    v_mfma_f32_16x16x32_bf16 v[164:167], v[24:27], v[128:131], v[164:167]
    v_mfma_f32_16x16x32_bf16 v[196:199], v[28:31], v[128:131], v[196:199]
    s_waitcnt lgkmcnt(0)
    v_mfma_f32_16x16x32_bf16 v[136:139], v[32:35], v[104:107], v[136:139]
    v_mfma_f32_16x16x32_bf16 v[168:171], v[36:39], v[104:107], v[168:171]
    s_waitcnt vmcnt(5)
    v_sub_u32 v6, v7, v6
    s_barrier
    v_mfma_f32_16x16x32_bf16 v[140:143], v[32:35], v[108:111], v[140:143]
    ds_read_b64_tr_b16 v[16:17], v4 offset:0
    v_mfma_f32_16x16x32_bf16 v[172:175], v[36:39], v[108:111], v[172:175]
    ds_read_b64_tr_b16 v[18:19], v4 offset:256
    v_mfma_f32_16x16x32_bf16 v[144:147], v[32:35], v[112:115], v[144:147]
    ds_read_b64_tr_b16 v[20:21], v5 offset:0
    v_mfma_f32_16x16x32_bf16 v[176:179], v[36:39], v[112:115], v[176:179]
    ds_read_b64_tr_b16 v[22:23], v5 offset:256
    v_mfma_f32_16x16x32_bf16 v[148:151], v[32:35], v[116:119], v[148:151]
    ds_read_b128 v[48:51], v6 offset:0
    v_mfma_f32_16x16x32_bf16 v[180:183], v[36:39], v[116:119], v[180:183]
    ds_read_b128 v[52:55], v6 offset:256
    v_mfma_f32_16x16x32_bf16 v[152:155], v[32:35], v[120:123], v[152:155]
    ds_read_b128 v[56:59], v6 offset:512
    v_mfma_f32_16x16x32_bf16 v[184:187], v[36:39], v[120:123], v[184:187]
    ds_read_b128 v[60:63], v6 offset:768
    v_mfma_f32_16x16x32_bf16 v[156:159], v[32:35], v[124:127], v[156:159]
    ds_read_b128 v[64:67], v6 offset:1024
    v_mfma_f32_16x16x32_bf16 v[188:191], v[36:39], v[124:127], v[188:191]
    ds_read_b128 v[68:71], v6 offset:1280
    v_mfma_f32_16x16x32_bf16 v[160:163], v[32:35], v[128:131], v[160:163]
    ds_read_b128 v[72:75], v6 offset:1536
    v_mfma_f32_16x16x32_bf16 v[192:195], v[36:39], v[128:131], v[192:195]
    ds_read_b128 v[76:79], v6 offset:1792
    v_mfma_f32_16x16x32_bf16 v[164:167], v[32:35], v[132:135], v[164:167]
    s_add_u32 s19, s19, 1
    s_mov_b32 s22, s20
    s_add_u32 s20, s20, 131072
    s_add_u32 s21, s21, 128
    s_sub_u32 s18, s36, s18
    s_cmp_lt_u32 s19, 7
    v_mfma_f32_16x16x32_bf16 v[196:199], v[36:39], v[132:135], v[196:199]
    s_cbranch_scc1 L_loop
    s_waitcnt lgkmcnt(0)
    ds_read_b64_tr_b16 v[24:25], v4 offset:4096
    ds_read_b64_tr_b16 v[26:27], v4 offset:4352
    v_mfma_f32_16x16x32_bf16 v[136:139], v[16:19], v[48:51], v[136:139]
    ds_read_b64_tr_b16 v[32:33], v4 offset:8192
    v_mfma_f32_16x16x32_bf16 v[140:143], v[16:19], v[52:55], v[140:143]
    ds_read_b64_tr_b16 v[34:35], v4 offset:8448
    v_mfma_f32_16x16x32_bf16 v[144:147], v[16:19], v[56:59], v[144:147]
    ds_read_b128 v[80:83], v6 offset:2080
    v_mfma_f32_16x16x32_bf16 v[148:151], v[16:19], v[60:63], v[148:151]
    ds_read_b128 v[84:87], v6 offset:2336
    v_mfma_f32_16x16x32_bf16 v[152:155], v[16:19], v[64:67], v[152:155]
    s_add_u32 m0, s17, 40960
    s_add_u32 s37, s22, 10485760
    buffer_load_dwordx4 v1, s[8:11], s37 offen lds
    v_mfma_f32_16x16x32_bf16 v[156:159], v[16:19], v[68:71], v[156:159]
    s_add_u32 m0, s17, 45056
    s_add_u32 s37, s22, 11534336
    buffer_load_dwordx4 v1, s[8:11], s37 offen lds
    v_mfma_f32_16x16x32_bf16 v[160:163], v[16:19], v[72:75], v[160:163]
    v_mfma_f32_16x16x32_bf16 v[164:167], v[16:19], v[76:79], v[164:167]
    s_waitcnt lgkmcnt(1)
    v_mfma_f32_16x16x32_bf16 v[136:139], v[24:27], v[52:55], v[136:139]
    ds_read_b64_tr_b16 v[40:41], v4 offset:12288
    v_mfma_f32_16x16x32_bf16 v[140:143], v[24:27], v[56:59], v[140:143]
    ds_read_b64_tr_b16 v[42:43], v4 offset:12544
    v_mfma_f32_16x16x32_bf16 v[144:147], v[24:27], v[60:63], v[144:147]
    ds_read_b128 v[88:91], v6 offset:2592
    v_mfma_f32_16x16x32_bf16 v[148:151], v[24:27], v[64:67], v[148:151]
    s_add_u32 m0, s17, 49152
    s_add_u32 s37, s22, 12582912
    buffer_load_dwordx4 v1, s[8:11], s37 offen lds
    v_mfma_f32_16x16x32_bf16 v[152:155], v[24:27], v[68:71], v[152:155]
    s_add_u32 m0, s17, 53248
    s_add_u32 s37, s22, 13631488
    buffer_load_dwordx4 v1, s[8:11], s37 offen lds
    v_mfma_f32_16x16x32_bf16 v[156:159], v[24:27], v[72:75], v[156:159]
    v_mfma_f32_16x16x32_bf16 v[160:163], v[24:27], v[76:79], v[160:163]
    v_mfma_f32_16x16x32_bf16 v[164:167], v[24:27], v[80:83], v[164:167]
    s_waitcnt lgkmcnt(3)
    v_mfma_f32_16x16x32_bf16 v[136:139], v[32:35], v[56:59], v[136:139]
    ds_read_b64_tr_b16 v[16:17], v4 offset:16384
    v_mfma_f32_16x16x32_bf16 v[140:143], v[32:35], v[60:63], v[140:143]
    ds_read_b64_tr_b16 v[18:19], v4 offset:16640
    v_mfma_f32_16x16x32_bf16 v[144:147], v[32:35], v[64:67], v[144:147]
    ds_read_b128 v[92:95], v6 offset:2848
    v_mfma_f32_16x16x32_bf16 v[148:151], v[32:35], v[68:71], v[148:151]
    s_add_u32 m0, s17, 57344
    s_add_u32 s37, s22, 14680064
    buffer_load_dwordx4 v1, s[8:11], s37 offen lds
    v_mfma_f32_16x16x32_bf16 v[152:155], v[32:35], v[72:75], v[152:155]
    v_mfma_f32_16x16x32_bf16 v[156:159], v[32:35], v[76:79], v[156:159]
    v_mfma_f32_16x16x32_bf16 v[160:163], v[32:35], v[80:83], v[160:163]
    v_mfma_f32_16x16x32_bf16 v[164:167], v[32:35], v[84:87], v[164:167]
    s_waitcnt lgkmcnt(3)
    v_mfma_f32_16x16x32_bf16 v[136:139], v[40:43], v[60:63], v[136:139]
    s_waitcnt vmcnt(5)
    s_barrier
    v_mfma_f32_16x16x32_bf16 v[140:143], v[40:43], v[64:67], v[140:143]
    ds_read_b64_tr_b16 v[24:25], v4 offset:20480
    v_mfma_f32_16x16x32_bf16 v[144:147], v[40:43], v[68:71], v[144:147]
    ds_read_b64_tr_b16 v[26:27], v4 offset:20736
    v_mfma_f32_16x16x32_bf16 v[148:151], v[40:43], v[72:75], v[148:151]
    ds_read_b128 v[96:99], v6 offset:3104
    v_mfma_f32_16x16x32_bf16 v[152:155], v[40:43], v[76:79], v[152:155]
    v_mfma_f32_16x16x32_bf16 v[156:159], v[40:43], v[80:83], v[156:159]
    v_mfma_f32_16x16x32_bf16 v[160:163], v[40:43], v[84:87], v[160:163]
    v_mfma_f32_16x16x32_bf16 v[164:167], v[40:43], v[88:91], v[164:167]
    s_waitcnt lgkmcnt(3)
    v_mfma_f32_16x16x32_bf16 v[136:139], v[16:19], v[64:67], v[136:139]
    ds_read_b64_tr_b16 v[32:33], v4 offset:24576
    v_mfma_f32_16x16x32_bf16 v[140:143], v[16:19], v[68:71], v[140:143]
    ds_read_b64_tr_b16 v[34:35], v4 offset:24832
    v_mfma_f32_16x16x32_bf16 v[144:147], v[16:19], v[72:75], v[144:147]
    ds_read_b128 v[100:103], v6 offset:3360
    v_mfma_f32_16x16x32_bf16 v[148:151], v[16:19], v[76:79], v[148:151]
    v_mfma_f32_16x16x32_bf16 v[152:155], v[16:19], v[80:83], v[152:155]
    v_mfma_f32_16x16x32_bf16 v[156:159], v[16:19], v[84:87], v[156:159]
    v_mfma_f32_16x16x32_bf16 v[160:163], v[16:19], v[88:91], v[160:163]
    v_mfma_f32_16x16x32_bf16 v[164:167], v[16:19], v[92:95], v[164:167]
    s_waitcnt lgkmcnt(3)
    v_mfma_f32_16x16x32_bf16 v[136:139], v[24:27], v[68:71], v[136:139]
    ds_read_b64_tr_b16 v[40:41], v4 offset:28672
    v_mfma_f32_16x16x32_bf16 v[140:143], v[24:27], v[72:75], v[140:143]
    ds_read_b64_tr_b16 v[42:43], v4 offset:28928
    v_mfma_f32_16x16x32_bf16 v[144:147], v[24:27], v[76:79], v[144:147]
    ds_read_b128 v[104:107], v6 offset:3616
    v_mfma_f32_16x16x32_bf16 v[148:151], v[24:27], v[80:83], v[148:151]
    v_mfma_f32_16x16x32_bf16 v[152:155], v[24:27], v[84:87], v[152:155]
    v_mfma_f32_16x16x32_bf16 v[156:159], v[24:27], v[88:91], v[156:159]
    v_mfma_f32_16x16x32_bf16 v[160:163], v[24:27], v[92:95], v[160:163]
    v_mfma_f32_16x16x32_bf16 v[164:167], v[24:27], v[96:99], v[164:167]
    s_waitcnt lgkmcnt(3)
    v_mfma_f32_16x16x32_bf16 v[136:139], v[32:35], v[72:75], v[136:139]
    ds_read_b64_tr_b16 v[16:17], v4 offset:32768
    v_mfma_f32_16x16x32_bf16 v[140:143], v[32:35], v[76:79], v[140:143]
    ds_read_b64_tr_b16 v[18:19], v4 offset:33024
    v_mfma_f32_16x16x32_bf16 v[144:147], v[32:35], v[80:83], v[144:147]
    ds_read_b128 v[108:111], v6 offset:3872
    v_mfma_f32_16x16x32_bf16 v[148:151], v[32:35], v[84:87], v[148:151]
    v_mfma_f32_16x16x32_bf16 v[152:155], v[32:35], v[88:91], v[152:155]
    v_mfma_f32_16x16x32_bf16 v[156:159], v[32:35], v[92:95], v[156:159]
    v_mfma_f32_16x16x32_bf16 v[160:163], v[32:35], v[96:99], v[160:163]
    v_mfma_f32_16x16x32_bf16 v[164:167], v[32:35], v[100:103], v[164:167]
    s_waitcnt lgkmcnt(3)
    v_mfma_f32_16x16x32_bf16 v[136:139], v[40:43], v[76:79], v[136:139]
    ds_read_b64_tr_b16 v[24:25], v4 offset:36864
    v_mfma_f32_16x16x32_bf16 v[140:143], v[40:43], v[80:83], v[140:143]
    ds_read_b64_tr_b16 v[26:27], v4 offset:37120
    v_mfma_f32_16x16x32_bf16 v[144:147], v[40:43], v[84:87], v[144:147]
    ds_read_b128 v[112:115], v6 offset:4160
    v_mfma_f32_16x16x32_bf16 v[148:151], v[40:43], v[88:91], v[148:151]
    v_mfma_f32_16x16x32_bf16 v[152:155], v[40:43], v[92:95], v[152:155]
    v_mfma_f32_16x16x32_bf16 v[156:159], v[40:43], v[96:99], v[156:159]
    v_mfma_f32_16x16x32_bf16 v[160:163], v[40:43], v[100:103], v[160:163]
    v_mfma_f32_16x16x32_bf16 v[164:167], v[40:43], v[104:107], v[164:167]
    s_waitcnt lgkmcnt(3)
    v_mfma_f32_16x16x32_bf16 v[136:139], v[16:19], v[80:83], v[136:139]
    s_waitcnt vmcnt(0)
    s_barrier
    v_mfma_f32_16x16x32_bf16 v[140:143], v[16:19], v[84:87], v[140:143]
    ds_read_b64_tr_b16 v[32:33], v4 offset:40960
    v_mfma_f32_16x16x32_bf16 v[144:147], v[16:19], v[88:91], v[144:147]
    ds_read_b64_tr_b16 v[34:35], v4 offset:41216
    v_mfma_f32_16x16x32_bf16 v[148:151], v[16:19], v[92:95], v[148:151]
    ds_read_b128 v[116:119], v6 offset:4416
    v_mfma_f32_16x16x32_bf16 v[152:155], v[16:19], v[96:99], v[152:155]
    v_mfma_f32_16x16x32_bf16 v[156:159], v[16:19], v[100:103], v[156:159]
    v_mfma_f32_16x16x32_bf16 v[160:163], v[16:19], v[104:107], v[160:163]
    v_mfma_f32_16x16x32_bf16 v[164:167], v[16:19], v[108:111], v[164:167]
    s_waitcnt lgkmcnt(3)
    v_mfma_f32_16x16x32_bf16 v[136:139], v[24:27], v[84:87], v[136:139]
    ds_read_b64_tr_b16 v[40:41], v4 offset:45056
    v_mfma_f32_16x16x32_bf16 v[140:143], v[24:27], v[88:91], v[140:143]
    ds_read_b64_tr_b16 v[42:43], v4 offset:45312
    v_mfma_f32_16x16x32_bf16 v[144:147], v[24:27], v[92:95], v[144:147]
    ds_read_b128 v[120:123], v6 offset:4672
    v_mfma_f32_16x16x32_bf16 v[148:151], v[24:27], v[96:99], v[148:151]
    v_mfma_f32_16x16x32_bf16 v[152:155], v[24:27], v[100:103], v[152:155]
    v_mfma_f32_16x16x32_bf16 v[156:159], v[24:27], v[104:107], v[156:159]
    v_mfma_f32_16x16x32_bf16 v[160:163], v[24:27], v[108:111], v[160:163]
    v_mfma_f32_16x16x32_bf16 v[164:167], v[24:27], v[112:115], v[164:167]
    s_waitcnt lgkmcnt(3)
    v_mfma_f32_16x16x32_bf16 v[136:139], v[32:35], v[88:91], v[136:139]
    ds_read_b64_tr_b16 v[16:17], v4 offset:49152
    v_mfma_f32_16x16x32_bf16 v[140:143], v[32:35], v[92:95], v[140:143]
    ds_read_b64_tr_b16 v[18:19], v4 offset:49408
    v_mfma_f32_16x16x32_bf16 v[144:147], v[32:35], v[96:99], v[144:147]
    ds_read_b128 v[124:127], v6 offset:4928
    v_mfma_f32_16x16x32_bf16 v[148:151], v[32:35], v[100:103], v[148:151]
    v_mfma_f32_16x16x32_bf16 v[152:155], v[32:35], v[104:107], v[152:155]
    v_mfma_f32_16x16x32_bf16 v[156:159], v[32:35], v[108:111], v[156:159]
    v_mfma_f32_16x16x32_bf16 v[160:163], v[32:35], v[112:115], v[160:163]
    v_mfma_f32_16x16x32_bf16 v[164:167], v[32:35], v[116:119], v[164:167]
    s_waitcnt lgkmcnt(3)
    v_mfma_f32_16x16x32_bf16 v[136:139], v[40:43], v[92:95], v[136:139]
    ds_read_b64_tr_b16 v[24:25], v4 offset:53248
    v_mfma_f32_16x16x32_bf16 v[140:143], v[40:43], v[96:99], v[140:143]
    ds_read_b64_tr_b16 v[26:27], v4 offset:53504
    v_mfma_f32_16x16x32_bf16 v[144:147], v[40:43], v[100:103], v[144:147]
    ds_read_b128 v[128:131], v6 offset:5184
    v_mfma_f32_16x16x32_bf16 v[148:151], v[40:43], v[104:107], v[148:151]
    v_mfma_f32_16x16x32_bf16 v[152:155], v[40:43], v[108:111], v[152:155]
    v_mfma_f32_16x16x32_bf16 v[156:159], v[40:43], v[112:115], v[156:159]
    v_mfma_f32_16x16x32_bf16 v[160:163], v[40:43], v[116:119], v[160:163]
    v_mfma_f32_16x16x32_bf16 v[164:167], v[40:43], v[120:123], v[164:167]
    s_waitcnt lgkmcnt(3)
    v_mfma_f32_16x16x32_bf16 v[136:139], v[16:19], v[96:99], v[136:139]
    ds_read_b64_tr_b16 v[32:33], v4 offset:57344
    v_mfma_f32_16x16x32_bf16 v[140:143], v[16:19], v[100:103], v[140:143]
    ds_read_b64_tr_b16 v[34:35], v4 offset:57600
    v_mfma_f32_16x16x32_bf16 v[144:147], v[16:19], v[104:107], v[144:147]
    ds_read_b128 v[132:135], v6 offset:5440
    v_mfma_f32_16x16x32_bf16 v[148:151], v[16:19], v[108:111], v[148:151]
    v_mfma_f32_16x16x32_bf16 v[152:155], v[16:19], v[112:115], v[152:155]
    v_mfma_f32_16x16x32_bf16 v[156:159], v[16:19], v[116:119], v[156:159]
    v_mfma_f32_16x16x32_bf16 v[160:163], v[16:19], v[120:123], v[160:163]
    v_mfma_f32_16x16x32_bf16 v[164:167], v[16:19], v[124:127], v[164:167]
    s_waitcnt lgkmcnt(3)
    v_mfma_f32_16x16x32_bf16 v[136:139], v[24:27], v[100:103], v[136:139]
    ds_read_b64_tr_b16 v[44:45], v5 offset:0
    v_mfma_f32_16x16x32_bf16 v[140:143], v[24:27], v[104:107], v[140:143]
    ds_read_b64_tr_b16 v[46:47], v5 offset:256
    v_mfma_f32_16x16x32_bf16 v[144:147], v[24:27], v[108:111], v[144:147]
    v_mfma_f32_16x16x32_bf16 v[148:151], v[24:27], v[112:115], v[148:151]
    v_mfma_f32_16x16x32_bf16 v[152:155], v[24:27], v[116:119], v[152:155]
    v_mfma_f32_16x16x32_bf16 v[156:159], v[24:27], v[120:123], v[156:159]
    v_mfma_f32_16x16x32_bf16 v[160:163], v[24:27], v[124:127], v[160:163]
    v_mfma_f32_16x16x32_bf16 v[164:167], v[24:27], v[128:131], v[164:167]
    s_waitcnt lgkmcnt(2)
    v_mfma_f32_16x16x32_bf16 v[136:139], v[32:35], v[104:107], v[136:139]
    ds_read_b64_tr_b16 v[20:21], v5 offset:4096
    v_mfma_f32_16x16x32_bf16 v[140:143], v[32:35], v[108:111], v[140:143]
    ds_read_b64_tr_b16 v[22:23], v5 offset:4352
    v_mfma_f32_16x16x32_bf16 v[144:147], v[32:35], v[112:115], v[144:147]
    v_mfma_f32_16x16x32_bf16 v[148:151], v[32:35], v[116:119], v[148:151]
    v_mfma_f32_16x16x32_bf16 v[152:155], v[32:35], v[120:123], v[152:155]
    v_mfma_f32_16x16x32_bf16 v[156:159], v[32:35], v[124:127], v[156:159]
    v_mfma_f32_16x16x32_bf16 v[160:163], v[32:35], v[128:131], v[160:163]
    v_mfma_f32_16x16x32_bf16 v[164:167], v[32:35], v[132:135], v[164:167]
    s_waitcnt lgkmcnt(2)
    v_mfma_f32_16x16x32_bf16 v[168:171], v[44:47], v[48:51], v[168:171]
    ds_read_b64_tr_b16 v[28:29], v5 offset:8192
    v_mfma_f32_16x16x32_bf16 v[172:175], v[44:47], v[52:55], v[172:175]
    ds_read_b64_tr_b16 v[30:31], v5 offset:8448
    v_mfma_f32_16x16x32_bf16 v[176:179], v[44:47], v[56:59], v[176:179]
    v_mfma_f32_16x16x32_bf16 v[180:183], v[44:47], v[60:63], v[180:183]
    v_mfma_f32_16x16x32_bf16 v[184:187], v[44:47], v[64:67], v[184:187]
    v_mfma_f32_16x16x32_bf16 v[188:191], v[44:47], v[68:71], v[188:191]
    v_mfma_f32_16x16x32_bf16 v[192:195], v[44:47], v[72:75], v[192:195]
    s_cmp_eq_u32 s56, 0
    s_cbranch_scc1 L_k0
    ds_write_b128 v11, v[136:139] offset:0
    ds_write_b128 v11, v[140:143] offset:1024
    ds_write_b128 v11, v[144:147] offset:2048
    ds_write_b128 v11, v[148:151] offset:3072
    v_mul_f32 v200, s38, v152
    v_mul_f32 v201, s38, v153
    v_mul_f32 v202, s38, v154
    v_mul_f32 v203, s38, v155
    v_mul_f32 v204, s38, v156
    v_mul_f32 v205, s38, v157
    v_mul_f32 v206, s38, v158
    v_mul_f32 v207, s38, v159
    v_mul_f32 v208, s38, v160
    v_mul_f32 v209, s38, v161
    v_mul_f32 v210, s38, v162
    v_mul_f32 v211, s38, v163
    v_mul_f32 v212, s38, v164
    v_mul_f32 v213, s38, v165
    v_mul_f32 v214, s38, v166
    v_mul_f32 v215, s38, v167
    s_branch L_k0d
L_k0:
    ds_write_b128 v11, v[152:155] offset:0
    ds_write_b128 v11, v[156:159] offset:1024
    ds_write_b128 v11, v[160:163] offset:2048
    ds_write_b128 v11, v[164:167] offset:3072
    v_mul_f32 v200, s38, v136
    v_mul_f32 v201, s38, v137
    v_mul_f32 v202, s38, v138
    v_mul_f32 v203, s38, v139
    v_mul_f32 v204, s38, v140
    v_mul_f32 v205, s38, v141
    v_mul_f32 v206, s38, v142
    v_mul_f32 v207, s38, v143
    v_mul_f32 v208, s38, v144
    v_mul_f32 v209, s38, v145
    v_mul_f32 v210, s38, v146
    v_mul_f32 v211, s38, v147
    v_mul_f32 v212, s38, v148
    v_mul_f32 v213, s38, v149
    v_mul_f32 v214, s38, v150
    v_mul_f32 v215, s38, v151
L_k0d:
    v_mfma_f32_16x16x32_bf16 v[196:199], v[44:47], v[76:79], v[196:199]
    s_waitcnt lgkmcnt(2)
    v_mfma_f32_16x16x32_bf16 v[168:171], v[20:23], v[52:55], v[168:171]
    ds_read_b64_tr_b16 v[36:37], v5 offset:12288
    v_mfma_f32_16x16x32_bf16 v[172:175], v[20:23], v[56:59], v[172:175]
    ds_read_b64_tr_b16 v[38:39], v5 offset:12544
    v_mfma_f32_16x16x32_bf16 v[176:179], v[20:23], v[60:63], v[176:179]
    v_mfma_f32_16x16x32_bf16 v[180:183], v[20:23], v[64:67], v[180:183]
    s_waitcnt lgkmcnt(0)
    s_barrier
    v_mfma_f32_16x16x32_bf16 v[184:187], v[20:23], v[68:71], v[184:187]
    ds_read_b128 v[216:219], v13 offset:0
    v_mfma_f32_16x16x32_bf16 v[188:191], v[20:23], v[72:75], v[188:191]
    ds_read_b128 v[220:223], v13 offset:1024
    v_mfma_f32_16x16x32_bf16 v[192:195], v[20:23], v[76:79], v[192:195]
    ds_read_b128 v[224:227], v13 offset:2048
    v_mfma_f32_16x16x32_bf16 v[196:199], v[20:23], v[80:83], v[196:199]
    ds_read_b128 v[228:231], v13 offset:3072
    v_mfma_f32_16x16x32_bf16 v[168:171], v[28:31], v[56:59], v[168:171]
    ds_read_b64_tr_b16 v[44:45], v5 offset:16384
    v_mfma_f32_16x16x32_bf16 v[172:175], v[28:31], v[60:63], v[172:175]
    ds_read_b64_tr_b16 v[46:47], v5 offset:16640
    v_mfma_f32_16x16x32_bf16 v[176:179], v[28:31], v[64:67], v[176:179]
    v_mfma_f32_16x16x32_bf16 v[180:183], v[28:31], v[68:71], v[180:183]
    v_mfma_f32_16x16x32_bf16 v[184:187], v[28:31], v[72:75], v[184:187]
    v_mfma_f32_16x16x32_bf16 v[188:191], v[28:31], v[76:79], v[188:191]
    v_mfma_f32_16x16x32_bf16 v[192:195], v[28:31], v[80:83], v[192:195]
    v_mfma_f32_16x16x32_bf16 v[196:199], v[28:31], v[84:87], v[196:199]
    v_mfma_f32_16x16x32_bf16 v[168:171], v[36:39], v[60:63], v[168:171]
    ds_read_b64_tr_b16 v[20:21], v5 offset:20480
    v_mfma_f32_16x16x32_bf16 v[172:175], v[36:39], v[64:67], v[172:175]
    ds_read_b64_tr_b16 v[22:23], v5 offset:20736
    v_mfma_f32_16x16x32_bf16 v[176:179], v[36:39], v[68:71], v[176:179]
    s_waitcnt lgkmcnt(4)
    v_mfma_f32_16x16x32_bf16 v[180:183], v[36:39], v[72:75], v[180:183]
    v_fmac_f32 v200, s38, v216
    v_fmac_f32 v201, s38, v217
    v_fmac_f32 v202, s38, v218
    v_fmac_f32 v203, s38, v219
    v_mfma_f32_16x16x32_bf16 v[184:187], v[36:39], v[76:79], v[184:187]
    v_fmac_f32 v204, s38, v220
    v_fmac_f32 v205, s38, v221
    v_fmac_f32 v206, s38, v222
    v_fmac_f32 v207, s38, v223
    v_mfma_f32_16x16x32_bf16 v[188:191], v[36:39], v[80:83], v[188:191]
    v_fmac_f32 v208, s38, v224
    v_fmac_f32 v209, s38, v225
    v_fmac_f32 v210, s38, v226
    v_fmac_f32 v211, s38, v227
    v_mfma_f32_16x16x32_bf16 v[192:195], v[36:39], v[84:87], v[192:195]
    v_fmac_f32 v212, s38, v228
    v_fmac_f32 v213, s38, v229
    v_fmac_f32 v214, s38, v230
    v_fmac_f32 v215, s38, v231
    v_mfma_f32_16x16x32_bf16 v[196:199], v[36:39], v[88:91], v[196:199]
    v_exp_f32 v200, v200
    v_exp_f32 v201, v201
    s_waitcnt lgkmcnt(2)
    v_mfma_f32_16x16x32_bf16 v[168:171], v[44:47], v[64:67], v[168:171]
    ds_read_b64_tr_b16 v[28:29], v5 offset:24576
    v_mfma_f32_16x16x32_bf16 v[172:175], v[44:47], v[68:71], v[172:175]
    ds_read_b64_tr_b16 v[30:31], v5 offset:24832
    v_mfma_f32_16x16x32_bf16 v[176:179], v[44:47], v[72:75], v[176:179]
    v_exp_f32 v202, v202
    v_exp_f32 v203, v203
    v_mfma_f32_16x16x32_bf16 v[180:183], v[44:47], v[76:79], v[180:183]
    v_exp_f32 v204, v204
    v_exp_f32 v205, v205
    v_mfma_f32_16x16x32_bf16 v[184:187], v[44:47], v[80:83], v[184:187]
    v_exp_f32 v206, v206
    v_exp_f32 v207, v207
    v_mfma_f32_16x16x32_bf16 v[188:191], v[44:47], v[84:87], v[188:191]
    v_exp_f32 v208, v208
    v_exp_f32 v209, v209
    v_mfma_f32_16x16x32_bf16 v[192:195], v[44:47], v[88:91], v[192:195]
    v_exp_f32 v210, v210
    v_exp_f32 v211, v211
    v_mfma_f32_16x16x32_bf16 v[196:199], v[44:47], v[92:95], v[196:199]
    v_exp_f32 v212, v212
    v_exp_f32 v213, v213
    s_waitcnt lgkmcnt(2)
    v_mfma_f32_16x16x32_bf16 v[168:171], v[20:23], v[68:71], v[168:171]
    ds_read_b64_tr_b16 v[36:37], v5 offset:28672
    v_mfma_f32_16x16x32_bf16 v[172:175], v[20:23], v[72:75], v[172:175]
    ds_read_b64_tr_b16 v[38:39], v5 offset:28928
    v_mfma_f32_16x16x32_bf16 v[176:179], v[20:23], v[76:79], v[176:179]
    v_exp_f32 v214, v214
    v_exp_f32 v215, v215
    v_mfma_f32_16x16x32_bf16 v[180:183], v[20:23], v[80:83], v[180:183]
    v_add_f32 v200, 1.0, v200
    v_add_f32 v201, 1.0, v201
    v_add_f32 v202, 1.0, v202
    v_add_f32 v203, 1.0, v203
    v_mfma_f32_16x16x32_bf16 v[184:187], v[20:23], v[84:87], v[184:187]
    v_add_f32 v204, 1.0, v204
    v_add_f32 v205, 1.0, v205
    v_add_f32 v206, 1.0, v206
    v_add_f32 v207, 1.0, v207
    v_mfma_f32_16x16x32_bf16 v[188:191], v[20:23], v[88:91], v[188:191]
    v_add_f32 v208, 1.0, v208
    v_add_f32 v209, 1.0, v209
    v_add_f32 v210, 1.0, v210
    v_add_f32 v211, 1.0, v211
    v_mfma_f32_16x16x32_bf16 v[192:195], v[20:23], v[92:95], v[192:195]
    v_add_f32 v212, 1.0, v212
    v_add_f32 v213, 1.0, v213
    v_add_f32 v214, 1.0, v214
    v_add_f32 v215, 1.0, v215
    v_mfma_f32_16x16x32_bf16 v[196:199], v[20:23], v[96:99], v[196:199]
    v_rcp_f32 v200, v200
    v_rcp_f32 v201, v201
    s_waitcnt lgkmcnt(2)
    v_mfma_f32_16x16x32_bf16 v[168:171], v[28:31], v[72:75], v[168:171]
    ds_read_b64_tr_b16 v[44:45], v5 offset:32768
    v_mfma_f32_16x16x32_bf16 v[172:175], v[28:31], v[76:79], v[172:175]
    ds_read_b64_tr_b16 v[46:47], v5 offset:33024
    v_mfma_f32_16x16x32_bf16 v[176:179], v[28:31], v[80:83], v[176:179]
    v_rcp_f32 v202, v202
    v_rcp_f32 v203, v203
    v_mfma_f32_16x16x32_bf16 v[180:183], v[28:31], v[84:87], v[180:183]
    v_rcp_f32 v204, v204
    v_rcp_f32 v205, v205
    v_mfma_f32_16x16x32_bf16 v[184:187], v[28:31], v[88:91], v[184:187]
    v_rcp_f32 v206, v206
    v_rcp_f32 v207, v207
    v_mfma_f32_16x16x32_bf16 v[188:191], v[28:31], v[92:95], v[188:191]
    v_rcp_f32 v208, v208
    v_rcp_f32 v209, v209
    v_mfma_f32_16x16x32_bf16 v[192:195], v[28:31], v[96:99], v[192:195]
    v_rcp_f32 v210, v210
    v_rcp_f32 v211, v211
    v_mfma_f32_16x16x32_bf16 v[196:199], v[28:31], v[100:103], v[196:199]
    v_rcp_f32 v212, v212
    v_rcp_f32 v213, v213
    s_waitcnt lgkmcnt(2)
    v_mfma_f32_16x16x32_bf16 v[168:171], v[36:39], v[76:79], v[168:171]
    ds_read_b64_tr_b16 v[20:21], v5 offset:36864
    v_mfma_f32_16x16x32_bf16 v[172:175], v[36:39], v[80:83], v[172:175]
    ds_read_b64_tr_b16 v[22:23], v5 offset:37120
    v_mfma_f32_16x16x32_bf16 v[176:179], v[36:39], v[84:87], v[176:179]
    v_rcp_f32 v214, v214
    v_rcp_f32 v215, v215
    v_mfma_f32_16x16x32_bf16 v[180:183], v[36:39], v[88:91], v[180:183]
    v_fma_f32 v200, s39, v200, v15
    v_fma_f32 v201, s39, v201, v15
    v_fma_f32 v202, s39, v202, v15
    v_fma_f32 v203, s39, v203, v15
    v_mfma_f32_16x16x32_bf16 v[184:187], v[36:39], v[92:95], v[184:187]
    v_fma_f32 v204, s39, v204, v15
    v_fma_f32 v205, s39, v205, v15
    v_fma_f32 v206, s39, v206, v15
    v_fma_f32 v207, s39, v207, v15
    v_mfma_f32_16x16x32_bf16 v[188:191], v[36:39], v[96:99], v[188:191]
    v_fma_f32 v208, s39, v208, v15
    v_fma_f32 v209, s39, v209, v15
    v_fma_f32 v210, s39, v210, v15
    v_fma_f32 v211, s39, v211, v15
    v_mfma_f32_16x16x32_bf16 v[192:195], v[36:39], v[100:103], v[192:195]
    v_fma_f32 v212, s39, v212, v15
    v_fma_f32 v213, s39, v213, v15
    v_fma_f32 v214, s39, v214, v15
    v_fma_f32 v215, s39, v215, v15
    v_mfma_f32_16x16x32_bf16 v[196:199], v[36:39], v[104:107], v[196:199]
    v_cvt_pk_bf16_f32 v216, v200, v201
    v_mov_b32 v217, v8
    v_cvt_pk_bf16_f32 v218, v202, v203
    v_mov_b32 v219, v8
    s_waitcnt lgkmcnt(2)
    v_mfma_f32_16x16x32_bf16 v[168:171], v[44:47], v[80:83], v[168:171]
    ds_read_b64_tr_b16 v[28:29], v5 offset:40960
    v_mfma_f32_16x16x32_bf16 v[172:175], v[44:47], v[84:87], v[172:175]
    ds_read_b64_tr_b16 v[30:31], v5 offset:41216
    v_mfma_f32_16x16x32_bf16 v[176:179], v[44:47], v[88:91], v[176:179]
    v_cvt_pk_bf16_f32 v220, v204, v205
    v_mov_b32 v221, v8
    v_cvt_pk_bf16_f32 v222, v206, v207
    v_mov_b32 v223, v8
    v_mfma_f32_16x16x32_bf16 v[180:183], v[44:47], v[92:95], v[180:183]
    v_cvt_pk_bf16_f32 v224, v208, v209
    v_mov_b32 v225, v8
    v_cvt_pk_bf16_f32 v226, v210, v211
    v_mov_b32 v227, v8
    v_mfma_f32_16x16x32_bf16 v[184:187], v[44:47], v[96:99], v[184:187]
    v_cvt_pk_bf16_f32 v228, v212, v213
    v_mov_b32 v229, v8
    v_cvt_pk_bf16_f32 v230, v214, v215
    v_mov_b32 v231, v8
    v_mfma_f32_16x16x32_bf16 v[188:191], v[44:47], v[100:103], v[188:191]
    buffer_store_dwordx4 v[216:219], v12, s[48:51], s23 offen offset:0 sc1
    v_mfma_f32_16x16x32_bf16 v[192:195], v[44:47], v[104:107], v[192:195]
    buffer_store_dwordx4 v[220:223], v12, s[48:51], s23 offen offset:1024 sc1
    v_mfma_f32_16x16x32_bf16 v[196:199], v[44:47], v[108:111], v[196:199]
    buffer_store_dwordx4 v[224:227], v12, s[48:51], s23 offen offset:2048 sc1
    s_waitcnt lgkmcnt(2)
    v_mfma_f32_16x16x32_bf16 v[168:171], v[20:23], v[84:87], v[168:171]
    ds_read_b64_tr_b16 v[36:37], v5 offset:45056
    v_mfma_f32_16x16x32_bf16 v[172:175], v[20:23], v[88:91], v[172:175]
    ds_read_b64_tr_b16 v[38:39], v5 offset:45312
    v_mfma_f32_16x16x32_bf16 v[176:179], v[20:23], v[92:95], v[176:179]
    buffer_store_dwordx4 v[228:231], v12, s[48:51], s23 offen offset:3072 sc1
    v_mfma_f32_16x16x32_bf16 v[180:183], v[20:23], v[96:99], v[180:183]
    v_mfma_f32_16x16x32_bf16 v[184:187], v[20:23], v[100:103], v[184:187]
    v_mfma_f32_16x16x32_bf16 v[188:191], v[20:23], v[104:107], v[188:191]
    v_mfma_f32_16x16x32_bf16 v[192:195], v[20:23], v[108:111], v[192:195]
    v_mfma_f32_16x16x32_bf16 v[196:199], v[20:23], v[112:115], v[196:199]
    s_waitcnt lgkmcnt(2)
    v_mfma_f32_16x16x32_bf16 v[168:171], v[28:31], v[88:91], v[168:171]
    ds_read_b64_tr_b16 v[44:45], v5 offset:49152
    v_mfma_f32_16x16x32_bf16 v[172:175], v[28:31], v[92:95], v[172:175]
    ds_read_b64_tr_b16 v[46:47], v5 offset:49408
    v_mfma_f32_16x16x32_bf16 v[176:179], v[28:31], v[96:99], v[176:179]
    v_mfma_f32_16x16x32_bf16 v[180:183], v[28:31], v[100:103], v[180:183]
    v_mfma_f32_16x16x32_bf16 v[184:187], v[28:31], v[104:107], v[184:187]
    v_mfma_f32_16x16x32_bf16 v[188:191], v[28:31], v[108:111], v[188:191]
    v_mfma_f32_16x16x32_bf16 v[192:195], v[28:31], v[112:115], v[192:195]
    v_mfma_f32_16x16x32_bf16 v[196:199], v[28:31], v[116:119], v[196:199]
    s_waitcnt lgkmcnt(2)
    v_mfma_f32_16x16x32_bf16 v[168:171], v[36:39], v[92:95], v[168:171]
    ds_read_b64_tr_b16 v[20:21], v5 offset:53248
    v_mfma_f32_16x16x32_bf16 v[172:175], v[36:39], v[96:99], v[172:175]
    ds_read_b64_tr_b16 v[22:23], v5 offset:53504
    v_mfma_f32_16x16x32_bf16 v[176:179], v[36:39], v[100:103], v[176:179]
    v_mfma_f32_16x16x32_bf16 v[180:183], v[36:39], v[104:107], v[180:183]
    v_mfma_f32_16x16x32_bf16 v[184:187], v[36:39], v[108:111], v[184:187]
    v_mfma_f32_16x16x32_bf16 v[188:191], v[36:39], v[112:115], v[188:191]
    v_mfma_f32_16x16x32_bf16 v[192:195], v[36:39], v[116:119], v[192:195]
    v_mfma_f32_16x16x32_bf16 v[196:199], v[36:39], v[120:123], v[196:199]
    s_waitcnt lgkmcnt(2)
    v_mfma_f32_16x16x32_bf16 v[168:171], v[44:47], v[96:99], v[168:171]
    ds_read_b64_tr_b16 v[28:29], v5 offset:57344
    v_mfma_f32_16x16x32_bf16 v[172:175], v[44:47], v[100:103], v[172:175]
    ds_read_b64_tr_b16 v[30:31], v5 offset:57600
    v_mfma_f32_16x16x32_bf16 v[176:179], v[44:47], v[104:107], v[176:179]
    v_mfma_f32_16x16x32_bf16 v[180:183], v[44:47], v[108:111], v[180:183]
    v_mfma_f32_16x16x32_bf16 v[184:187], v[44:47], v[112:115], v[184:187]
    v_mfma_f32_16x16x32_bf16 v[188:191], v[44:47], v[116:119], v[188:191]
    v_mfma_f32_16x16x32_bf16 v[192:195], v[44:47], v[120:123], v[192:195]
    v_mfma_f32_16x16x32_bf16 v[196:199], v[44:47], v[124:127], v[196:199]
    s_waitcnt lgkmcnt(2)
    v_mfma_f32_16x16x32_bf16 v[168:171], v[20:23], v[100:103], v[168:171]
    v_mfma_f32_16x16x32_bf16 v[172:175], v[20:23], v[104:107], v[172:175]
    v_mfma_f32_16x16x32_bf16 v[176:179], v[20:23], v[108:111], v[176:179]
    v_mfma_f32_16x16x32_bf16 v[180:183], v[20:23], v[112:115], v[180:183]
    v_mfma_f32_16x16x32_bf16 v[184:187], v[20:23], v[116:119], v[184:187]
    v_mfma_f32_16x16x32_bf16 v[188:191], v[20:23], v[120:123], v[188:191]
    v_mfma_f32_16x16x32_bf16 v[192:195], v[20:23], v[124:127], v[192:195]
    v_mfma_f32_16x16x32_bf16 v[196:199], v[20:23], v[128:131], v[196:199]
    s_waitcnt lgkmcnt(0)
    v_mfma_f32_16x16x32_bf16 v[168:171], v[28:31], v[104:107], v[168:171]
    v_mfma_f32_16x16x32_bf16 v[172:175], v[28:31], v[108:111], v[172:175]
    v_mfma_f32_16x16x32_bf16 v[176:179], v[28:31], v[112:115], v[176:179]
    v_mfma_f32_16x16x32_bf16 v[180:183], v[28:31], v[116:119], v[180:183]
    v_mfma_f32_16x16x32_bf16 v[184:187], v[28:31], v[120:123], v[184:187]
    v_mfma_f32_16x16x32_bf16 v[188:191], v[28:31], v[124:127], v[188:191]
    v_mfma_f32_16x16x32_bf16 v[192:195], v[28:31], v[128:131], v[192:195]
    v_mfma_f32_16x16x32_bf16 v[196:199], v[28:31], v[132:135], v[196:199]
    s_nop 7
    s_cmp_eq_u32 s56, 0
    s_cbranch_scc1 L_p0
    ds_write_b128 v11, v[168:171] offset:16384
    ds_write_b128 v11, v[172:175] offset:17408
    ds_write_b128 v11, v[176:179] offset:18432
    ds_write_b128 v11, v[180:183] offset:19456
    v_mul_f32 v48, s38, v184
    v_mul_f32 v49, s38, v185
    v_mul_f32 v50, s38, v186
    v_mul_f32 v51, s38, v187
    v_mul_f32 v52, s38, v188
    v_mul_f32 v53, s38, v189
    v_mul_f32 v54, s38, v190
    v_mul_f32 v55, s38, v191
    v_mul_f32 v56, s38, v192
    v_mul_f32 v57, s38, v193
    v_mul_f32 v58, s38, v194
    v_mul_f32 v59, s38, v195
    v_mul_f32 v60, s38, v196
    v_mul_f32 v61, s38, v197
    v_mul_f32 v62, s38, v198
    v_mul_f32 v63, s38, v199
    s_branch L_p0d
L_p0:
    ds_write_b128 v11, v[184:187] offset:16384
    ds_write_b128 v11, v[188:191] offset:17408
    ds_write_b128 v11, v[192:195] offset:18432
    ds_write_b128 v11, v[196:199] offset:19456
    v_mul_f32 v48, s38, v168
    v_mul_f32 v49, s38, v169
    v_mul_f32 v50, s38, v170
    v_mul_f32 v51, s38, v171
    v_mul_f32 v52, s38, v172
    v_mul_f32 v53, s38, v173
    v_mul_f32 v54, s38, v174
    v_mul_f32 v55, s38, v175
    v_mul_f32 v56, s38, v176
    v_mul_f32 v57, s38, v177
    v_mul_f32 v58, s38, v178
    v_mul_f32 v59, s38, v179
    v_mul_f32 v60, s38, v180
    v_mul_f32 v61, s38, v181
    v_mul_f32 v62, s38, v182
    v_mul_f32 v63, s38, v183
L_p0d:
    s_waitcnt lgkmcnt(0)
    s_barrier
    ds_read_b128 v[64:67], v13 offset:16384
    ds_read_b128 v[68:71], v13 offset:17408
    ds_read_b128 v[72:75], v13 offset:18432
    ds_read_b128 v[76:79], v13 offset:19456
    buffer_load_dwordx4 v[80:83], v12, s[48:51], s58 offen offset:0 sc1
    buffer_load_dwordx4 v[84:87], v12, s[48:51], s58 offen offset:1024 sc1
    buffer_load_dwordx4 v[88:91], v12, s[48:51], s58 offen offset:2048 sc1
    buffer_load_dwordx4 v[92:95], v12, s[48:51], s58 offen offset:3072 sc1
    s_waitcnt lgkmcnt(0)
    v_fmac_f32 v48, s38, v64
    v_fmac_f32 v49, s38, v65
    v_fmac_f32 v50, s38, v66
    v_fmac_f32 v51, s38, v67
    v_fmac_f32 v52, s38, v68
    v_fmac_f32 v53, s38, v69
    v_fmac_f32 v54, s38, v70
    v_fmac_f32 v55, s38, v71
    v_fmac_f32 v56, s38, v72
    v_fmac_f32 v57, s38, v73
    v_fmac_f32 v58, s38, v74
    v_fmac_f32 v59, s38, v75
    v_fmac_f32 v60, s38, v76
    v_fmac_f32 v61, s38, v77
    v_fmac_f32 v62, s38, v78
    v_fmac_f32 v63, s38, v79
    v_exp_f32 v48, v48
    v_exp_f32 v49, v49
    v_exp_f32 v50, v50
    v_exp_f32 v51, v51
    v_exp_f32 v52, v52
    v_exp_f32 v53, v53
    v_exp_f32 v54, v54
    v_exp_f32 v55, v55
    v_exp_f32 v56, v56
    v_exp_f32 v57, v57
    v_exp_f32 v58, v58
    v_exp_f32 v59, v59
    v_exp_f32 v60, v60
    v_exp_f32 v61, v61
    v_exp_f32 v62, v62
    v_exp_f32 v63, v63
    s_nop 0
    v_add_f32 v48, 1.0, v48
    v_add_f32 v49, 1.0, v49
    v_add_f32 v50, 1.0, v50
    v_add_f32 v51, 1.0, v51
    v_add_f32 v52, 1.0, v52
    v_add_f32 v53, 1.0, v53
    v_add_f32 v54, 1.0, v54
    v_add_f32 v55, 1.0, v55
    v_add_f32 v56, 1.0, v56
    v_add_f32 v57, 1.0, v57
    v_add_f32 v58, 1.0, v58
    v_add_f32 v59, 1.0, v59
    v_add_f32 v60, 1.0, v60
    v_add_f32 v61, 1.0, v61
    v_add_f32 v62, 1.0, v62
    v_add_f32 v63, 1.0, v63
    v_rcp_f32 v48, v48
    v_rcp_f32 v49, v49
    v_rcp_f32 v50, v50
    v_rcp_f32 v51, v51
    v_rcp_f32 v52, v52
    v_rcp_f32 v53, v53
    v_rcp_f32 v54, v54
    v_rcp_f32 v55, v55
    v_rcp_f32 v56, v56
    v_rcp_f32 v57, v57
    v_rcp_f32 v58, v58
    v_rcp_f32 v59, v59
    v_rcp_f32 v60, v60
    v_rcp_f32 v61, v61
    v_rcp_f32 v62, v62
    v_rcp_f32 v63, v63
    s_nop 0
    v_fma_f32 v48, s39, v48, v15
    v_fma_f32 v49, s39, v49, v15
    v_fma_f32 v50, s39, v50, v15
    v_fma_f32 v51, s39, v51, v15
    v_fma_f32 v52, s39, v52, v15
    v_fma_f32 v53, s39, v53, v15
    v_fma_f32 v54, s39, v54, v15
    v_fma_f32 v55, s39, v55, v15
    v_fma_f32 v56, s39, v56, v15
    v_fma_f32 v57, s39, v57, v15
    v_fma_f32 v58, s39, v58, v15
    v_fma_f32 v59, s39, v59, v15
    v_fma_f32 v60, s39, v60, v15
    v_fma_f32 v61, s39, v61, v15
    v_fma_f32 v62, s39, v62, v15
    v_fma_f32 v63, s39, v63, v15
    s_mov_b32 s34, 0
    s_branch L_chk
L_poll:
    buffer_load_dwordx4 v[80:83], v12, s[48:51], s58 offen offset:0 sc1
    buffer_load_dwordx4 v[84:87], v12, s[48:51], s58 offen offset:1024 sc1
    buffer_load_dwordx4 v[88:91], v12, s[48:51], s58 offen offset:2048 sc1
    buffer_load_dwordx4 v[92:95], v12, s[48:51], s58 offen offset:3072 sc1
L_chk:
    s_add_u32 s34, s34, 1
    s_waitcnt vmcnt(0)
    v_or3_b32 v96, v81, v83, v85
    v_or3_b32 v97, v87, v89, v91
    v_or3_b32 v96, v96, v93, v95
    v_and_b32 v98, v81, v83
    v_and_b32 v99, v85, v87
    v_and_b32 v100, v89, v91
    v_and_b32 v101, v93, v95
    v_or_b32 v96, v96, v97
    v_and_b32 v98, v98, v99
    v_and_b32 v100, v100, v101
    v_xor_b32 v96, v96, v8
    v_and_b32 v98, v98, v100
    v_xor_b32 v98, v98, v8
    v_or_b32 v96, v96, v98
    v_cmp_ne_u32 vcc, 0, v96
    s_cmp_gt_u32 s34, 0x40000
    s_cbranch_scc1 L_got
    s_cbranch_vccnz L_poll
L_got:
    v_lshlrev_b32 v96, 16, v80
    v_and_b32 v97, 0xffff0000, v80
    v_lshlrev_b32 v98, 16, v82
    v_and_b32 v99, 0xffff0000, v82
    v_lshlrev_b32 v100, 16, v84
    v_and_b32 v101, 0xffff0000, v84
    v_lshlrev_b32 v102, 16, v86
    v_and_b32 v103, 0xffff0000, v86
    v_lshlrev_b32 v104, 16, v88
    v_and_b32 v105, 0xffff0000, v88
    v_lshlrev_b32 v106, 16, v90
    v_and_b32 v107, 0xffff0000, v90
    v_lshlrev_b32 v108, 16, v92
    v_and_b32 v109, 0xffff0000, v92
    v_lshlrev_b32 v110, 16, v94
    v_and_b32 v111, 0xffff0000, v94
    v_mul_f32 v48, v48, v96
    v_mul_f32 v49, v49, v97
    v_mul_f32 v50, v50, v98
    v_mul_f32 v51, v51, v99
    v_mul_f32 v52, v52, v100
    v_mul_f32 v53, v53, v101
    v_mul_f32 v54, v54, v102
    v_mul_f32 v55, v55, v103
    v_mul_f32 v56, v56, v104
    v_mul_f32 v57, v57, v105
    v_mul_f32 v58, v58, v106
    v_mul_f32 v59, v59, v107
    v_mul_f32 v60, v60, v108
    v_mul_f32 v61, v61, v109
    v_mul_f32 v62, v62, v110
    v_mul_f32 v63, v63, v111
    v_cvt_pk_bf16_f32 v64, v48, v49
    v_cvt_pk_bf16_f32 v65, v50, v51
    v_cvt_pk_bf16_f32 v66, v52, v53
    v_cvt_pk_bf16_f32 v67, v54, v55
    v_cvt_pk_bf16_f32 v68, v56, v57
    v_cvt_pk_bf16_f32 v69, v58, v59
    v_cvt_pk_bf16_f32 v70, v60, v61
    v_cvt_pk_bf16_f32 v71, v62, v63
    v_add_u32 v9, 4096, v14
    buffer_store_dwordx2 v[64:65], v14, s[12:15], 0 offen offset:0
    buffer_store_dwordx2 v[66:67], v14, s[12:15], 0 offen offset:2048
    buffer_store_dwordx2 v[68:69], v9, s[12:15], 0 offen offset:0
    buffer_store_dwordx2 v[70:71], v9, s[12:15], 0 offen offset:2048
    s_endpgm
L_helper:
    s_lshl_b32 s34, s44, 6
    v_add_u32 v12, s34, v0
    v_lshrrev_b32 v13, 7, v12
    v_lshlrev_b32 v13, 20, v13
    v_bfe_u32 v14, v12, 1, 6
    v_lshlrev_b32 v14, 11, v14
    v_add_u32 v13, v13, v14
    v_and_b32 v14, 1, v12
    v_mul_u32_u24 v14, 1152, v14
    v_xor_b32 v14, s45, v14
    v_add_u32 v13, v13, v14
    v_lshlrev_b32 v14, 10, v12
    s_waitcnt lgkmcnt(0)
    s_mov_b32 s8, s26
    s_and_b32 s9, s27, 0xffff
    s_mov_b32 s10, 15728640
    s_mov_b32 s11, 0x20000
    s_mov_b32 s4, s24
    s_and_b32 s5, s25, 0xffff
    s_mov_b32 s6, 2048000
    s_mov_b32 s7, 0x20000
    buffer_load_dword v16, v13, s[8:11], 0 offen
    s_waitcnt vmcnt(0)
    s_mov_b32 s34, 131072
    buffer_load_dword v16, v13, s[8:11], s34 offen
    s_mov_b32 s34, 128
    buffer_load_dword v16, v14, s[4:7], s34 offen
    s_mov_b32 s52, s30
    s_and_b32 s53, s31, 0xffff
    s_mov_b32 s54, 256
    s_mov_b32 s55, 0x20000
    s_mov_b32 s12, s28
    s_and_b32 s13, s29, 0xffff
    s_mov_b32 s14, 2048000
    s_mov_b32 s15, 0x20000
    s_mov_b32 s48, s32
    s_and_b32 s49, s33, 0xffff
    s_mov_b32 s50, 0x400000
    s_mov_b32 s51, 0x20000
    v_mov_b32 v20, 0
    v_mov_b32 v21, 0
    v_mov_b32 v22, 0
    v_mov_b32 v23, 0
    v_lshlrev_b32 v24, 4, v0
    s_lshl_b32 s35, s2, 14
    v_mov_b32 v25, s2
    v_xor_b32 v26, 9, v25
    v_mov_b32 v27, 1
    s_lshr_b32 s36, s44, 1
    s_mul_i32 s36, s36, 11
    s_lshr_b32 s36, s36, 6
    s_barrier
    s_mov_b32 s34, 262144
    buffer_load_dword v16, v13, s[8:11], s34 offen
    s_mov_b32 s34, 256
    buffer_load_dword v16, v14, s[4:7], s34 offen
    s_barrier
    s_barrier
    s_barrier
    s_mov_b32 s34, 393216
    buffer_load_dword v16, v13, s[8:11], s34 offen
    s_mov_b32 s34, 384
    buffer_load_dword v16, v14, s[4:7], s34 offen
    buffer_store_dwordx4 v[20:23], v24, s[48:51], s35 offen sc1
    s_add_u32 s35, s35, 1024
    buffer_store_dwordx4 v[20:23], v24, s[48:51], s35 offen sc1
    s_add_u32 s35, s35, 1024
    buffer_store_dwordx4 v[20:23], v24, s[48:51], s35 offen sc1
    s_add_u32 s35, s35, 1024
    buffer_store_dwordx4 v[20:23], v24, s[48:51], s35 offen sc1
    s_add_u32 s35, s35, 1024
    buffer_store_dwordx4 v[20:23], v24, s[48:51], s35 offen sc1
    s_add_u32 s35, s35, 1024
    buffer_store_dwordx4 v[20:23], v24, s[48:51], s35 offen sc1
    s_add_u32 s35, s35, 1024
    buffer_store_dwordx4 v[20:23], v24, s[48:51], s35 offen sc1
    s_add_u32 s35, s35, 1024
    buffer_store_dwordx4 v[20:23], v24, s[48:51], s35 offen sc1
    s_add_u32 s35, s35, 1024
    s_barrier
    s_barrier
    s_barrier
    s_mov_b32 s34, 524288
    buffer_load_dword v16, v13, s[8:11], s34 offen
    s_mov_b32 s34, 512
    buffer_load_dword v16, v14, s[4:7], s34 offen
    buffer_store_dwordx4 v[20:23], v24, s[48:51], s35 offen sc1
    s_add_u32 s35, s35, 1024
    buffer_store_dwordx4 v[20:23], v24, s[48:51], s35 offen sc1
    s_add_u32 s35, s35, 1024
    buffer_store_dwordx4 v[20:23], v24, s[48:51], s35 offen sc1
    s_add_u32 s35, s35, 1024
    buffer_store_dwordx4 v[20:23], v24, s[48:51], s35 offen sc1
    s_add_u32 s35, s35, 1024
    buffer_store_dwordx4 v[20:23], v24, s[48:51], s35 offen sc1
    s_add_u32 s35, s35, 1024
    buffer_store_dwordx4 v[20:23], v24, s[48:51], s35 offen sc1
    s_add_u32 s35, s35, 1024
    buffer_store_dwordx4 v[20:23], v24, s[48:51], s35 offen sc1
    s_add_u32 s35, s35, 1024
    buffer_store_dwordx4 v[20:23], v24, s[48:51], s35 offen sc1
    s_add_u32 s35, s35, 1024
    s_barrier
    s_barrier
    s_barrier
    s_cmp_lg_u32 s36, 0
    s_cbranch_scc1 L_hnf9
    s_waitcnt vmcnt(0)
    s_mov_b64 exec, 1
    buffer_store_byte v27, v25, s[52:55], 0 offen sc1
    s_mov_b64 exec, -1
L_hnf9:
    s_mov_b32 s34, 655360
    buffer_load_dword v16, v13, s[8:11], s34 offen
    s_mov_b32 s34, 640
    buffer_load_dword v16, v14, s[4:7], s34 offen
    s_barrier
    s_barrier
    s_barrier
    s_cmp_lg_u32 s36, 1
    s_cbranch_scc1 L_hnf12
    s_waitcnt vmcnt(0)
    s_mov_b64 exec, 1
    buffer_store_byte v27, v25, s[52:55], 0 offen sc1
    s_mov_b64 exec, -1
L_hnf12:
    s_mov_b32 s34, 786432
    buffer_load_dword v16, v13, s[8:11], s34 offen
    s_mov_b32 s34, 768
    buffer_load_dword v16, v14, s[4:7], s34 offen
    s_barrier
    s_barrier
    s_barrier
    s_cmp_lg_u32 s36, 2
    s_cbranch_scc1 L_hnf15
    s_waitcnt vmcnt(0)
    s_mov_b64 exec, 1
    buffer_store_byte v27, v25, s[52:55], 0 offen sc1
    s_mov_b64 exec, -1
L_hnf15:
    s_mov_b32 s34, 917504
    buffer_load_dword v16, v13, s[8:11], s34 offen
    s_mov_b32 s34, 896
    buffer_load_dword v16, v14, s[4:7], s34 offen
    s_barrier
    s_barrier
    s_barrier
    s_mov_b32 s34, 0
L_hpoll:
    buffer_load_ubyte v28, v26, s[52:55], 0 offen sc1
    s_add_u32 s34, s34, 1
    s_waitcnt vmcnt(0)
    v_cmp_eq_u32 vcc, 0, v28
    s_cmp_gt_u32 s34, 0x40000
    s_cbranch_scc1 L_hgot
    s_cbranch_vccnz L_hpoll
L_hgot:
    s_barrier
    s_barrier
    s_barrier
L_end:
    s_endpgm
.section .rodata,"a"
.p2align 6
.amdhsa_kernel standalone__autoregressive_conv_wavernn__speech_kernel
  .amdhsa_next_free_vgpr 256
  .amdhsa_next_free_sgpr 100
  .amdhsa_accum_offset 256
  .amdhsa_group_segment_fixed_size 0
  .amdhsa_kernarg_size 40
  .amdhsa_user_sgpr_count 2
  .amdhsa_user_sgpr_kernarg_segment_ptr 1
  .amdhsa_system_sgpr_workgroup_id_x 1
.end_amdhsa_kernel
```
